```python
import torch

def _softmax(x, axis=-1):
    return torch.softmax(x, dim=axis)
def _gelu(x):
    return torch.nn.functional.gelu(x, approximate="tanh")
def _silu(x):
    return torch.nn.functional.silu(x)
def _sigmoid(x):
    return torch.sigmoid(x)
def _layernorm(x, axis=-1, eps=1e-5):
    m = x.mean(dim=axis, keepdim=True)
    v = x.var(dim=axis, keepdim=True, unbiased=False)
    return (x - m) / torch.sqrt(v + eps)
def _scatter_add(tgt, idx, src, axis=0):
    return tgt.clone().index_add_(axis, idx, src)
def _segment_sum(src, seg, n):
    out = torch.zeros((n,) + src.shape[1:], dtype=src.dtype)
    return out.index_add_(0, seg, src)
def _pad(x, pw):
    flat = tuple(v for pair in reversed(pw) for v in pair)
    return torch.nn.functional.pad(x, flat)

kernel_name = 'gated_mix__ssm_conv_s5__glu_gated_bilinear__prompt'

def setup_inputs():

    _w = (lambda a: (lambda t: t.to(torch.bfloat16) if t.is_floating_point() else t)(torch.as_tensor(a)))
    def _A_setup():
        B, S, D = 1, 2048, 512
        P = D
        Lambda_re = -0.5 * (lambda _x: torch.exp(torch.as_tensor(_x)))((lambda *s: torch.randn(*s, dtype=torch.bfloat16) * 0.2)(P))
        Lambda_im = (lambda *s: torch.randn(*s, dtype=torch.bfloat16) * 0.4)(P) * 1.0
        B_re = (lambda *s: torch.randn(*s, dtype=torch.bfloat16) * 0.2)(P, D) * (D ** -0.5)
        B_im = (lambda *s: torch.randn(*s, dtype=torch.bfloat16) * 0.2)(P, D) * (D ** -0.5)
        C_re = (lambda *s: torch.randn(*s, dtype=torch.bfloat16) * 0.2)(D, P) * (P ** -0.5)
        C_im = (lambda *s: torch.randn(*s, dtype=torch.bfloat16) * 0.2)(D, P) * (P ** -0.5)
        log_dt = (lambda *s: torch.randn(*s, dtype=torch.bfloat16) * 0.2)(P) * 0.3 - 2.0
        Dskip = (lambda *s: torch.randn(*s, dtype=torch.bfloat16) * 0.05)(D)
        return {
            "x": _w((lambda *s: torch.randn(*s, dtype=torch.bfloat16) * 0.05)(B, S, D)),
            "Lambda_re": _w(Lambda_re),
            "Lambda_im": _w(Lambda_im),
            "B_re": _w(B_re),
            "B_im": _w(B_im),
            "C_re": _w(C_re),
            "C_im": _w(C_im),
            "log_dt": _w(log_dt),
            "Dskip": _w(Dskip),
        }
    _A_in = _A_setup()

    def _B_setup():
        B, S, D, F = 1, 2048, 512, 1376
        return {
            "x": _w((lambda *s: torch.randn(*s, dtype=torch.bfloat16) * 0.05)(B, S, D)),
            "w_gate": _w((lambda *s: torch.randn(*s, dtype=torch.bfloat16) * 0.8)(D, F) * (D ** -0.5)),
            "w_up": _w((lambda *s: torch.randn(*s, dtype=torch.bfloat16) * 0.8)(D, F) * (D ** -0.5)),
            "w_down": _w((lambda *s: torch.randn(*s, dtype=torch.bfloat16) * 0.8)(F, D) * (F ** -0.5)),
        }
    _B_in = _B_setup()

    return {
        "A_x": _A_in["x"],
        "A_Lambda_re": _A_in["Lambda_re"],
        "A_Lambda_im": _A_in["Lambda_im"],
        "A_B_re": _A_in["B_re"],
        "A_B_im": _A_in["B_im"],
        "A_C_re": _A_in["C_re"],
        "A_C_im": _A_in["C_im"],
        "A_log_dt": _A_in["log_dt"],
        "A_Dskip": _A_in["Dskip"],
        "B_x": _B_in["x"],
        "B_w_gate": _B_in["w_gate"],
        "B_w_up": _B_in["w_up"],
        "B_w_down": _B_in["w_down"],
        "gate_w": _w((lambda *s: torch.randn(*s, dtype=torch.bfloat16) * 0.05)(512) * 16.0),
    }

def reference(A_x, A_Lambda_re, A_Lambda_im, A_B_re, A_B_im, A_C_re, A_C_im, A_log_dt, A_Dskip, B_x, B_w_gate, B_w_up, B_w_down, gate_w):
    def _A_ref(x, Lambda_re, Lambda_im, B_re, B_im, C_re, C_im, log_dt, Dskip):
        Bsz, L, H = x.shape
        Lam = Lambda_re + 1j * Lambda_im
        Bmat = B_re + 1j * B_im
        Cmat = C_re + 1j * C_im
        dt = torch.exp(log_dt)
        Lam_bar = torch.exp(dt * Lam)
        B_bar = ((Lam_bar - 1.0) / Lam)[:, None] * Bmat
        Bu = torch.einsum("bld,pd->blp", x + 0j, B_bar)
        h = torch.zeros_like(Bu[:, 0, :])
        hs = []
        for t in range(L):
            h = Lam_bar[None, :] * h + Bu[:, t, :]
            hs.append(h)
        hseq = torch.stack(hs, 1)
        y = 2.0 * torch.einsum("blp,dp->bld", hseq, Cmat).real + x * Dskip[None, None, :]
        return y

    def _B_ref(x, w_gate, w_up, w_down):
        g = torch.einsum("bsd,df->bsf", x, w_gate)
        u = torch.einsum("bsd,df->bsf", x, w_up)
        h = g * u
        return torch.einsum("bsf,fd->bsd", h, w_down)

    x = A_x
    g = _sigmoid((x * gate_w).sum(-1, keepdims=True))
    a = _A_ref(x, A_Lambda_re, A_Lambda_im, A_B_re, A_B_im, A_C_re, A_C_im, A_log_dt, A_Dskip)
    b = _B_ref(x, B_w_gate, B_w_up, B_w_down)
    return g * a + (1 - g) * b
```

```asm
; @launch grid=(256,1,1) block=(512,1,1) lds=163840
.amdgcn_target "amdgcn-amd-amdhsa--gfx950"
.text
.globl gated_mix__ssm_conv_s5__glu_gated_bilinear__prompt_kernel
.p2align 8
.type gated_mix__ssm_conv_s5__glu_gated_bilinear__prompt_kernel,@function
gated_mix__ssm_conv_s5__glu_gated_bilinear__prompt_kernel:
    s_cmp_ge_u32 s2, 256
    s_cbranch_scc1 L_end
    s_load_dwordx2 s[4:5], s[0:1], 0
    s_load_dwordx2 s[8:9], s[0:1], 24
    s_load_dwordx2 s[12:13], s[0:1], 32
    s_load_dwordx2 s[16:17], s[0:1], 80
    s_load_dwordx2 s[20:21], s[0:1], 88
    s_load_dwordx2 s[62:63], s[0:1], 120
    v_readfirstlane_b32 s64, v0
    v_and_b32 v1, 63, v0
    s_lshr_b32 s65, s2, 5
    s_bfe_u32 s74, s2, 65538
    s_lshl3_add_u32 s65, s74, s65
    s_bfe_u32 s66, s2, 131075
    s_and_b32 s74, s2, 3
    s_lshl2_add_u32 s66, s74, s66
    s_lshr_b32 s64, s64, 6
    s_xor_b32 s64, s64, 4
    s_mul_i32 s74, s66, 43
    s_lshr_b32 s74, s74, 7
    s_mul_i32 s67, s66, 3
    s_sub_u32 s67, s67, s74
    s_mul_i32 s74, s74, 3
    s_sub_u32 s73, s66, s74
    s_and_b32 s69, s64, 3
    s_mov_b32 s6, 2097152
    s_mov_b32 s7, 0x20000
    s_cmp_lt_u32 s64, 4
    s_cbranch_scc1 L_Cstart
L_Lstart:
    s_lshl_b32 s74, s69, 3
    s_add_u32 s74, s74, 8
    s_cmp_ge_u32 s69, 2
    s_cselect_b32 s74, 56, s74
    s_load_dwordx2 s[28:29], s[0:1], s74
    s_getpc_b64 s[74:75]
L_pc:
    s_lshr_b32 s76, s2, 3
    s_lshl2_add_u32 s76, s76, s69
    s_lshl_b32 s76, s76, 1
    v_add_lshl_u32 v26, s76, v1, 7
    v_cmp_gt_u32 vcc, L_codeend-L_pc, v26
    s_nop 0
    s_and_b64 exec, vcc, 3
    s_cbranch_execz L_nowarm
    global_load_dword v28, v26, s[74:75]
L_nowarm:
    s_mov_b64 exec, -1
    s_lshl2_add_u32 s3, s69, 150016
    v_lshl_add_u32 v26, v1, 4, s3
    v_and_b32 v27, 13, v1
    v_cmp_ne_u32 vcc, 8, v27
    v_mov_b64 v[22:23], -1
    v_lshlrev_b32 v24, 3, v0
    v_add_u32 v24, 147456, v24
    ds_write_b64 v24, v[22:23]
    v_cndmask_b32 v27, 0, 1, vcc
    s_mov_b64 exec, 0xfff
    ds_write_b32 v26, v27
    s_mov_b64 exec, -1
    s_mov_b32 s10, 524288
    s_mov_b32 s11, s7
    s_mov_b64 s[14:15], s[10:11]
    s_mov_b32 s18, 1409024
    s_mov_b32 s19, s7
    s_mov_b64 s[22:23], s[18:19]
    s_add_u32 s68, s65, s66
    s_and_b32 s68, s68, 7
    s_mul_i32 s68, s68, 0x11111111
    s_and_b32 s68, s68, 286331153
    s_xor_b32 s68, s68, 0x76543210
    v_lshrrev_b32 v17, 3, v1
    v_and_b32 v18, 7, v1
    v_lshrrev_b32 v16, 5, v1
    v_and_b32 v20, 3, v17
    v_lshl_add_u32 v19, v16, 4, v20
    s_lshl_b32 s74, s65, 7
    s_lshr_b32 s75, s69, 1
    s_lshl_b32 s75, s75, 6
    s_add_u32 s74, s74, s75
    s_and_b32 s76, s69, 1
    s_lshl_b32 s75, s76, 3
    s_add_u32 s74, s74, s75
    v_add_u32 v19, s74, v19
    v_lshrrev_b32 v20, 4, v1
    v_xor_b32 v20, v20, v18
    v_lshlrev_b32 v20, 4, v20
    v_lshl_add_u32 v2, v19, 10, v20
    v_xor_b32 v3, 64, v2
    v_add_u32 v3, 0x8000, v3
    s_lshl_b32 s74, s66, 5
    s_lshl_b32 s75, s69, 3
    s_add_u32 s74, s74, s75
    v_add_u32 v19, s74, v17
    v_lshl_add_u32 v4, v19, 10, v20
    s_lshl_b32 s75, s76, 6
    v_xor_b32 v4, s75, v4
    v_lshrrev_b32 v19, 2, v1
    s_lshl_b32 s74, s69, 4
    v_add_u32 v19, s74, v19
    v_mul_u32_u24 v19, 2752, v19
    v_and_b32 v21, 3, v1
    v_lshlrev_b32 v16, 1, v16
    v_xor_b32 v21, v21, v16
    v_lshl_add_u32 v19, v21, 4, v19
    s_lshl_b32 s74, s67, 6
    v_add_u32 v5, s74, v19
    s_cmp_eq_u32 s73, 2
    s_cselect_b32 s74, 0x40000000, 128
    v_add_u32 v6, s74, v5
    v_mov_b32 v30, 128
    s_mov_b32 s77, 0
    s_mov_b32 s78, 0
    s_lshl_b32 s51, s69, 12
    s_lshl_b32 s56, s69, 10
    s_add_u32 s56, s56, 16384
    s_mov_b32 s31, 0
    s_setprio 2
    s_getpc_b64 s[60:61]
L_pc2:
    s_add_u32 s60, s60, L_Lgo-L_pc2
    s_addc_u32 s61, s61, 0
    s_lshl_b32 s74, s66, 6
    v_lshl_add_u32 v26, v1, 2, s74
    s_lshl_b32 s74, s69, 6
    s_add_u32 m0, s74, 150528
    s_mov_b64 exec, 0xffff
    s_waitcnt lgkmcnt(0)
    global_load_lds_dword v26, s[28:29]
    s_mov_b64 exec, -1
    s_branch L_dma0
L_dma:
    s_barrier
L_dma0:
    s_and_b32 s74, s68, 7
    s_lshr_b32 s68, s68, 4
    s_lshl_b32 s48, s74, 7
    s_add_u32 m0, s78, s51
    s_add_u32 s49, s48, 4096
    buffer_load_dwordx4 v2, s[4:7], s48 offen lds
    s_add_u32 m0, m0, 1024
    s_mul_i32 s50, s74, 176128
    buffer_load_dwordx4 v3, s[4:7], s48 offen lds
    s_add_u32 m0, m0, 1024
    s_nop 0
    buffer_load_dwordx4 v2, s[4:7], s49 offen lds
    s_add_u32 m0, m0, 1024
    s_nop 0
    buffer_load_dwordx4 v3, s[4:7], s49 offen lds
    s_add_u32 m0, s78, s56
    s_add_u32 s78, s78, 49152
    buffer_load_dwordx4 v4, s[8:11], s48 offen lds
    s_add_u32 m0, m0, 4096
    s_cmp_eq_u32 s78, 147456
    buffer_load_dwordx4 v4, s[12:15], s48 offen lds
    s_cselect_b32 s78, 0, s78
    s_add_u32 m0, m0, 4096
    s_nop 0
    buffer_load_dwordx4 v5, s[16:19], s50 offen lds
    s_add_u32 m0, m0, 4032
    s_nop 0
    buffer_load_dwordx4 v5, s[16:19], s50 offen offset:64 lds
    s_add_u32 m0, m0, 4160
    s_cmp_eq_u32 s73, 2
    s_cbranch_scc1 L_sk16
    buffer_load_dwordx4 v6, s[16:19], s50 offen lds
L_sk16:
    s_add_u32 m0, m0, 4096
    s_nop 0
    buffer_load_dwordx4 v5, s[20:23], s50 offen lds
    s_add_u32 m0, m0, 4032
    s_nop 0
    buffer_load_dwordx4 v5, s[20:23], s50 offen offset:64 lds
    s_add_u32 m0, m0, 4160
    s_cmp_eq_u32 s73, 2
    s_cbranch_scc1 L_sk20
    buffer_load_dwordx4 v6, s[20:23], s50 offen lds
L_sk20:
    s_mov_b32 m0, s3
    s_mov_b64 exec, 1
    global_load_lds_dword v30, s[62:63]
    s_mov_b64 exec, -1
    s_add_u32 s3, s3, 16
    s_sub_u32 s31, s31, 1
    s_cbranch_scc1 L_dmaret
    s_load_dword s30, s[28:29], 0
    s_load_dword s30, s[28:29], 64
    s_load_dword s30, s[28:29], 128
    s_load_dword s30, s[28:29], 192
    s_load_dword s30, s[28:29], 256
    s_load_dword s30, s[28:29], 320
    s_load_dword s30, s[28:29], 384
    s_load_dword s30, s[28:29], 448
    s_add_u32 s28, s28, 512
    s_addc_u32 s29, s29, 0
    s_branch L_dmaret2
L_dmaret:
    s_mov_b32 s31, 0
L_dmaret2:
    s_add_u32 s77, s77, 1
    s_setpc_b64 s[60:61]
L_Cstart:
    s_load_dwordx2 s[24:25], s[0:1], 128
    s_load_dwordx2 s[36:37], s[0:1], 96
    s_load_dwordx2 s[44:45], s[0:1], 112
    s_load_dwordx4 s[52:55], s[0:1], 40
    s_load_dwordx2 s[60:61], s[0:1], 104
    s_load_dwordx2 s[58:59], s[0:1], 64
    s_memrealtime s[50:51]
    s_setprio 3
    s_lshl2_add_u32 s74, s64, 150176
    v_mov_b32 v29, s74
    v_mov_b32 v30, 0
    s_and_b32 s68, s64, 1
    s_waitcnt lgkmcnt(0)
    s_or_b32 s74, s2, s64
    s_cbranch_scc1 L_C
    s_or_b32 s51, s51, 0x80000000
    v_mov_b32 v76, s50
    v_mov_b32 v77, s51
    s_mov_b64 exec, 1
    global_store_dwordx2 v30, v[76:77], s[62:63] sc1
    s_mov_b64 exec, -1
L_C:
    s_lshl_b32 s74, s66, 13
    s_add_u32 s74, s74, 10485760
    s_add_u32 s28, s24, s74
    s_addc_u32 s29, s25, 0
    s_mov_b32 s30, 8192
    s_mov_b32 s31, 0x20000
    s_lshr_b32 s70, s2, 5
    s_bfe_u32 s74, s2, 131073
    s_lshl3_add_u32 s70, s74, s70
    s_bfe_u32 s71, s2, 131075
    s_and_b32 s74, s2, 1
    s_lshl2_add_u32 s71, s74, s71
    s_lshl_b32 s72, s70, 0
    s_and_b32 s72, s72, 7
    s_mov_b32 s26, 12582912
    s_mov_b32 s27, 0x20000
    s_mov_b32 s34, 307200
    s_mov_b32 s35, 0x20000
    s_mov_b32 s42, 524288
    s_mov_b32 s43, 0x20000
    s_mov_b32 s46, 4194304
    s_mov_b32 s47, 0x20000
    s_mul_i32 s74, s70, 307200
    s_add_u32 s32, s24, s74
    s_addc_u32 s33, s25, 0
    v_mov_b32 v31, 150016
    v_and_b32 v26, 15, v1
    v_lshrrev_b32 v27, 4, v1
    v_bfe_u32 v72, v1, 1, 3
    v_xor_b32 v72, v72, v27
    v_lshlrev_b32 v72, 4, v72
    v_lshl_add_u32 v4, v26, 7, v72
    v_xor_b32 v5, 64, v4
    s_lshl_b32 s74, s68, 13
    v_add_u32 v2, s74, v4
    v_add_u32 v3, s74, v5
    v_bfe_u32 v26, v1, 2, 2
    v_lshl_add_u32 v26, v27, 3, v26
    v_lshlrev_b32 v26, 6, v26
    v_and_b32 v72, 1, v27
    v_lshl_add_u32 v26, v72, 5, v26
    v_and_b32 v72, 3, v1
    v_lshl_add_u32 v6, v72, 3, v26
    v_xor_b32 v7, 32, v6
    v_mov_b64 v[128:129], 0
    v_mov_b64 v[130:131], 0
    v_mov_b64 v[132:133], 0
    v_mov_b64 v[134:135], 0
    v_mov_b64 v[136:137], 0
    v_mov_b64 v[138:139], 0
    v_mov_b64 v[140:141], 0
    v_mov_b64 v[142:143], 0
    v_mov_b64 v[144:145], 0
    v_mov_b64 v[146:147], 0
    v_mov_b64 v[148:149], 0
    v_mov_b64 v[150:151], 0
    v_mov_b64 v[152:153], 0
    v_mov_b64 v[154:155], 0
    v_mov_b64 v[156:157], 0
    v_mov_b64 v[158:159], 0
    v_mov_b64 v[160:161], 0
    v_mov_b64 v[162:163], 0
    v_mov_b64 v[164:165], 0
    v_mov_b64 v[166:167], 0
    v_mov_b64 v[168:169], 0
    v_mov_b64 v[170:171], 0
    v_mov_b64 v[172:173], 0
    v_mov_b64 v[174:175], 0
    v_mov_b64 v[176:177], 0
    v_mov_b64 v[178:179], 0
    v_mov_b64 v[180:181], 0
    v_mov_b64 v[182:183], 0
    v_mov_b64 v[184:185], 0
    v_mov_b64 v[186:187], 0
    v_mov_b64 v[188:189], 0
    v_mov_b64 v[190:191], 0
    v_mov_b64 v[192:193], 0
    v_mov_b64 v[194:195], 0
    v_mov_b64 v[196:197], 0
    v_mov_b64 v[198:199], 0
    v_mov_b64 v[200:201], 0
    v_mov_b64 v[202:203], 0
    v_mov_b64 v[204:205], 0
    v_mov_b64 v[206:207], 0
    v_mov_b64 v[208:209], 0
    v_mov_b64 v[210:211], 0
    v_mov_b64 v[212:213], 0
    v_mov_b64 v[214:215], 0
    v_mov_b64 v[216:217], 0
    v_mov_b64 v[218:219], 0
    v_mov_b64 v[220:221], 0
    v_mov_b64 v[222:223], 0
    v_mov_b64 v[224:225], 0
    v_mov_b64 v[226:227], 0
    v_mov_b64 v[228:229], 0
    v_mov_b64 v[230:231], 0
    v_mov_b64 v[232:233], 0
    v_mov_b64 v[234:235], 0
    v_mov_b64 v[236:237], 0
    v_mov_b64 v[238:239], 0
    v_mov_b64 v[240:241], 0
    v_mov_b64 v[242:243], 0
    v_mov_b64 v[244:245], 0
    v_mov_b64 v[246:247], 0
    v_mov_b64 v[248:249], 0
    v_mov_b64 v[250:251], 0
    v_mov_b64 v[252:253], 0
    v_mov_b64 v[254:255], 0
    s_mov_b32 s77, 0
    s_barrier
    s_cmp_lt_u32 s64, 2
    s_cbranch_scc1 L_C0
    s_branch L_C1
L_Lgo:
    s_load_dwordx2 s[24:25], s[0:1], 128
    s_load_dwordx2 s[36:37], s[0:1], 96
    s_load_dwordx2 s[44:45], s[0:1], 112
    s_load_dwordx4 s[52:55], s[0:1], 40
    s_load_dwordx2 s[58:59], s[0:1], 64
    v_mov_b32 v25, 150176
    s_waitcnt vmcnt(11)
    s_barrier
    s_setprio 1
    s_call_b64 s[60:61], L_dma0
    s_setprio 0
    s_waitcnt lgkmcnt(0)
    s_lshr_b32 s70, s2, 5
    s_bfe_u32 s74, s2, 131073
    s_lshl3_add_u32 s70, s74, s70
    s_bfe_u32 s71, s2, 131075
    s_and_b32 s74, s2, 1
    s_lshl2_add_u32 s71, s74, s71
    s_lshl_b32 s72, s70, 0
    s_and_b32 s72, s72, 7
    s_mov_b32 s26, 12582912
    s_mov_b32 s27, 0x20000
    s_mov_b32 s34, 307200
    s_mov_b32 s35, 0x20000
    s_mov_b32 s42, 524288
    s_mov_b32 s43, 0x20000
    s_mov_b32 s46, 4194304
    s_mov_b32 s47, 0x20000
    s_mul_i32 s74, s70, 307200
    s_add_u32 s32, s24, s74
    s_addc_u32 s33, s25, 0
    s_mov_b32 s38, 1409024
    s_mov_b32 s39, 0x20000
    s_cmp_eq_u32 s69, 2
    s_cselect_b64 s[28:29], s[52:53], s[54:55]
    s_lshl_b32 s74, s2, 1
    s_add_u32 s74, s74, s69
    s_mul_i32 s74, s74, 2752
    s_min_u32 s74, s74, 1405952
    s_lshl_b32 s75, s2, 11
    s_min_u32 s75, s75, 522240
    s_cmp_ge_u32 s69, 2
    s_cselect_b64 s[28:29], s[28:29], s[36:37]
    s_cselect_b32 s74, s75, s74
    s_cselect_b32 s79, 4, 6
    s_add_u32 s28, s28, s74
    s_addc_u32 s29, s29, 0
    v_bfe_u32 v21, v1, 4, 1
    v_lshlrev_b32 v21, 2, v21
    v_xor_b32 v21, v18, v21
    v_lshlrev_b32 v21, 4, v21
    v_lshl_add_u32 v21, v17, 10, v21
    s_lshl_b32 s74, s71, 7
    v_add_u32 v7, s74, v21
    s_lshl_b32 s74, s71, 6
    v_add_u32 v19, s74, v17
    v_lshl_add_u32 v8, v19, 10, v20
    v_xor_b32 v9, 64, v8
    v_lshlrev_b32 v26, 4, v1
    v_add_u32 v13, 131072, v26
    s_mov_b32 s74, 177689633
    s_movk_i32 s75, 2147
    s_cmp_eq_u32 s69, 1
    s_cmov_b32 s74, 177693729
    s_cmovk_i32 s75, 2131
    s_cmp_eq_u32 s69, 2
    s_cmov_b32 s74, 261579825
    s_cmovk_i32 s75, 2130
    v_lshlrev_b32 v19, 2, v1
    v_lshrrev_b64 v[32:33], v19, s[74:75]
    v_and_b32 v19, 15, v32
    s_mul_i32 s74, s69, 11
    s_cmp_eq_u32 s69, 3
    s_cselect_b32 s74, 32, s74
    v_cmp_eq_u32 vcc, 15, v19
    v_add_u32 v19, s74, v19
    s_nop 0
    v_cndmask_b32 v19, v19, 43, vcc
    v_lshlrev_b32 v10, 12, v19
    v_lshrrev_b32 v21, 5, v1
    v_bfe_u32 v19, v1, 2, 2
    v_lshl_add_u32 v19, v21, 2, v19
    v_lshlrev_b32 v19, 7, v19
    v_bfe_u32 v21, v1, 4, 1
    v_lshl_add_u32 v19, v21, 5, v19
    v_and_b32 v21, 3, v1
    v_lshl_add_u32 v19, v21, 3, v19
    v_bfe_u32 v21, v1, 3, 1
    v_lshl_add_u32 v19, v21, 6, v19
    s_mul_i32 s57, s69, 12288
    s_add_u32 s74, s57, 98304
    v_add_u32 v11, s74, v19
    v_xor_b32 v12, 64, v11
    s_mov_b32 s31, s79
    s_call_b64 s[60:61], L_dma0
    s_call_b64 s[60:61], L_dma
    s_call_b64 s[60:61], L_dma
    s_call_b64 s[60:61], L_dma
    s_call_b64 s[60:61], L_dma
    s_call_b64 s[60:61], L_dma
    v_mov_b32 v16, 0
    global_load_dwordx2 v[22:23], v16, s[62:63] sc1
    s_barrier
    v_readlane_b32 s74, v10, 0
    s_add_u32 m0, s57, 98304
    s_lshl_b32 s74, s74, 3
    s_nop 2
    buffer_load_dwordx4 v7, s[36:39], s74 offen lds
    s_add_u32 m0, m0, 1024
    s_add_u32 s74, s74, 8192
    buffer_load_dwordx4 v7, s[36:39], s74 offen lds
    s_add_u32 m0, m0, 1024
    s_add_u32 s74, s74, 8192
    buffer_load_dwordx4 v7, s[36:39], s74 offen lds
    s_add_u32 m0, m0, 1024
    s_add_u32 s74, s74, 8192
    buffer_load_dwordx4 v7, s[36:39], s74 offen lds
    v_readlane_b32 s74, v10, 1
    s_add_u32 m0, s57, 102400
    s_lshl_b32 s74, s74, 3
    s_nop 2
    buffer_load_dwordx4 v7, s[36:39], s74 offen lds
    s_add_u32 m0, m0, 1024
    s_add_u32 s74, s74, 8192
    buffer_load_dwordx4 v7, s[36:39], s74 offen lds
    s_add_u32 m0, m0, 1024
    s_add_u32 s74, s74, 8192
    buffer_load_dwordx4 v7, s[36:39], s74 offen lds
    s_add_u32 m0, m0, 1024
    s_add_u32 s74, s74, 8192
    buffer_load_dwordx4 v7, s[36:39], s74 offen lds
    v_readlane_b32 s74, v10, 2
    s_add_u32 m0, s57, 106496
    s_lshl_b32 s74, s74, 3
    s_nop 2
    buffer_load_dwordx4 v7, s[36:39], s74 offen lds
    s_add_u32 m0, m0, 1024
    s_add_u32 s74, s74, 8192
    buffer_load_dwordx4 v7, s[36:39], s74 offen lds
    s_add_u32 m0, m0, 1024
    s_add_u32 s74, s74, 8192
    buffer_load_dwordx4 v7, s[36:39], s74 offen lds
    s_add_u32 m0, m0, 1024
    s_add_u32 s74, s74, 8192
    buffer_load_dwordx4 v7, s[36:39], s74 offen lds
    s_waitcnt vmcnt(8)
    ds_read_b64_tr_b16 v[128:129], v11 offset:0
    ds_read_b64_tr_b16 v[130:131], v11 offset:2048
    ds_read_b64_tr_b16 v[132:133], v12 offset:0
    ds_read_b64_tr_b16 v[134:135], v12 offset:2048
    ds_read_b64_tr_b16 v[136:137], v11 offset:1024
    ds_read_b64_tr_b16 v[138:139], v11 offset:3072
    ds_read_b64_tr_b16 v[140:141], v12 offset:1024
    ds_read_b64_tr_b16 v[142:143], v12 offset:3072
    s_waitcnt lgkmcnt(0)
    v_readlane_b32 s74, v10, 3
    s_add_u32 m0, s57, 98304
    s_lshl_b32 s74, s74, 3
    s_nop 2
    buffer_load_dwordx4 v7, s[36:39], s74 offen lds
    s_add_u32 m0, m0, 1024
    s_add_u32 s74, s74, 8192
    buffer_load_dwordx4 v7, s[36:39], s74 offen lds
    s_add_u32 m0, m0, 1024
    s_add_u32 s74, s74, 8192
    buffer_load_dwordx4 v7, s[36:39], s74 offen lds
    s_add_u32 m0, m0, 1024
    s_add_u32 s74, s74, 8192
    buffer_load_dwordx4 v7, s[36:39], s74 offen lds
    s_mov_b32 s79, 0
L_tagL:
    v_readfirstlane_b32 s61, v23
    s_nop 0
    s_cmp_lg_u32 s61, 0
    s_cbranch_scc1 L_tagLok
    global_load_dwordx2 v[22:23], v16, s[62:63] sc1
    s_waitcnt vmcnt(0)
    s_add_u32 s79, s79, 1
    s_cmp_lt_u32 s79, 2097152
    s_cbranch_scc1 L_tagL
L_tagLok:
    v_readfirstlane_b32 s60, v22
    v_readlane_b32 s8, v10, 0
    v_readlane_b32 s9, v10, 1
    v_readlane_b32 s10, v10, 2
    v_readlane_b32 s11, v10, 3
    v_readlane_b32 s12, v10, 4
    v_readlane_b32 s13, v10, 5
    v_readlane_b32 s14, v10, 6
    v_readlane_b32 s15, v10, 7
    v_readlane_b32 s16, v10, 8
    v_readlane_b32 s17, v10, 9
    v_readlane_b32 s18, v10, 10
    s_lshl_b32 s48, s70, 13
    s_lshl_b32 s75, s69, 11
    s_add_u32 s48, s48, s75
    s_add_u32 s48, s48, 10747904
    v_lshrrev_b32 v14, 2, v1
    v_bfe_u32 v26, v1, 1, 1
    v_and_b32 v27, 1, v1
    v_lshl_add_u32 v6, v14, 1, v27
    v_lshl_add_u32 v14, v14, 2, v26
    v_lshlrev_b32 v14, 7, v14
    v_lshl_add_u32 v14, v27, 4, v14
    s_lshl_b32 s75, s69, 6
    s_add_u32 s75, s75, 149568
    v_lshl_add_u32 v6, v6, 3, s75
    s_waitcnt vmcnt(8)
    ds_read_b64_tr_b16 v[144:145], v11 offset:4096
    ds_read_b64_tr_b16 v[146:147], v11 offset:6144
    ds_read_b64_tr_b16 v[148:149], v12 offset:4096
    ds_read_b64_tr_b16 v[150:151], v12 offset:6144
    ds_read_b64_tr_b16 v[152:153], v11 offset:5120
    ds_read_b64_tr_b16 v[154:155], v11 offset:7168
    ds_read_b64_tr_b16 v[156:157], v12 offset:5120
    ds_read_b64_tr_b16 v[158:159], v12 offset:7168
    s_waitcnt lgkmcnt(0)
    v_readlane_b32 s74, v10, 4
    s_add_u32 m0, s57, 102400
    s_lshl_b32 s74, s74, 3
    s_nop 2
    buffer_load_dwordx4 v7, s[36:39], s74 offen lds
    s_add_u32 m0, m0, 1024
    s_add_u32 s74, s74, 8192
    buffer_load_dwordx4 v7, s[36:39], s74 offen lds
    s_add_u32 m0, m0, 1024
    s_add_u32 s74, s74, 8192
    buffer_load_dwordx4 v7, s[36:39], s74 offen lds
    s_add_u32 m0, m0, 1024
    s_add_u32 s74, s74, 8192
    buffer_load_dwordx4 v7, s[36:39], s74 offen lds
    s_waitcnt vmcnt(8)
    ds_read_b64_tr_b16 v[160:161], v11 offset:8192
    ds_read_b64_tr_b16 v[162:163], v11 offset:10240
    ds_read_b64_tr_b16 v[164:165], v12 offset:8192
    ds_read_b64_tr_b16 v[166:167], v12 offset:10240
    ds_read_b64_tr_b16 v[168:169], v11 offset:9216
    ds_read_b64_tr_b16 v[170:171], v11 offset:11264
    ds_read_b64_tr_b16 v[172:173], v12 offset:9216
    ds_read_b64_tr_b16 v[174:175], v12 offset:11264
    s_waitcnt lgkmcnt(0)
    v_readlane_b32 s74, v10, 5
    s_add_u32 m0, s57, 106496
    s_lshl_b32 s74, s74, 3
    s_nop 2
    buffer_load_dwordx4 v7, s[36:39], s74 offen lds
    s_add_u32 m0, m0, 1024
    s_add_u32 s74, s74, 8192
    buffer_load_dwordx4 v7, s[36:39], s74 offen lds
    s_add_u32 m0, m0, 1024
    s_add_u32 s74, s74, 8192
    buffer_load_dwordx4 v7, s[36:39], s74 offen lds
    s_add_u32 m0, m0, 1024
    s_add_u32 s74, s74, 8192
    buffer_load_dwordx4 v7, s[36:39], s74 offen lds
    s_waitcnt vmcnt(8)
    ds_read_b64_tr_b16 v[176:177], v11 offset:0
    ds_read_b64_tr_b16 v[178:179], v11 offset:2048
    ds_read_b64_tr_b16 v[180:181], v12 offset:0
    ds_read_b64_tr_b16 v[182:183], v12 offset:2048
    ds_read_b64_tr_b16 v[184:185], v11 offset:1024
    ds_read_b64_tr_b16 v[186:187], v11 offset:3072
    ds_read_b64_tr_b16 v[188:189], v12 offset:1024
    ds_read_b64_tr_b16 v[190:191], v12 offset:3072
    s_waitcnt lgkmcnt(0)
    v_readlane_b32 s74, v10, 6
    s_add_u32 m0, s57, 98304
    s_lshl_b32 s74, s74, 3
    s_nop 2
    buffer_load_dwordx4 v7, s[36:39], s74 offen lds
    s_add_u32 m0, m0, 1024
    s_add_u32 s74, s74, 8192
    buffer_load_dwordx4 v7, s[36:39], s74 offen lds
    s_add_u32 m0, m0, 1024
    s_add_u32 s74, s74, 8192
    buffer_load_dwordx4 v7, s[36:39], s74 offen lds
    s_add_u32 m0, m0, 1024
    s_add_u32 s74, s74, 8192
    buffer_load_dwordx4 v7, s[36:39], s74 offen lds
    s_waitcnt vmcnt(8)
    ds_read_b64_tr_b16 v[192:193], v11 offset:4096
    ds_read_b64_tr_b16 v[194:195], v11 offset:6144
    ds_read_b64_tr_b16 v[196:197], v12 offset:4096
    ds_read_b64_tr_b16 v[198:199], v12 offset:6144
    ds_read_b64_tr_b16 v[200:201], v11 offset:5120
    ds_read_b64_tr_b16 v[202:203], v11 offset:7168
    ds_read_b64_tr_b16 v[204:205], v12 offset:5120
    ds_read_b64_tr_b16 v[206:207], v12 offset:7168
    s_waitcnt lgkmcnt(0)
    v_readlane_b32 s74, v10, 7
    s_add_u32 m0, s57, 102400
    s_lshl_b32 s74, s74, 3
    s_nop 2
    buffer_load_dwordx4 v7, s[36:39], s74 offen lds
    s_add_u32 m0, m0, 1024
    s_add_u32 s74, s74, 8192
    buffer_load_dwordx4 v7, s[36:39], s74 offen lds
    s_add_u32 m0, m0, 1024
    s_add_u32 s74, s74, 8192
    buffer_load_dwordx4 v7, s[36:39], s74 offen lds
    s_add_u32 m0, m0, 1024
    s_add_u32 s74, s74, 8192
    buffer_load_dwordx4 v7, s[36:39], s74 offen lds
    s_waitcnt vmcnt(8)
    ds_read_b64_tr_b16 v[208:209], v11 offset:8192
    ds_read_b64_tr_b16 v[210:211], v11 offset:10240
    ds_read_b64_tr_b16 v[212:213], v12 offset:8192
    ds_read_b64_tr_b16 v[214:215], v12 offset:10240
    ds_read_b64_tr_b16 v[216:217], v11 offset:9216
    ds_read_b64_tr_b16 v[218:219], v11 offset:11264
    ds_read_b64_tr_b16 v[220:221], v12 offset:9216
    ds_read_b64_tr_b16 v[222:223], v12 offset:11264
    s_waitcnt lgkmcnt(0)
    v_readlane_b32 s74, v10, 8
    s_add_u32 m0, s57, 106496
    s_lshl_b32 s74, s74, 3
    s_nop 2
    buffer_load_dwordx4 v7, s[36:39], s74 offen lds
    s_add_u32 m0, m0, 1024
    s_add_u32 s74, s74, 8192
    buffer_load_dwordx4 v7, s[36:39], s74 offen lds
    s_add_u32 m0, m0, 1024
    s_add_u32 s74, s74, 8192
    buffer_load_dwordx4 v7, s[36:39], s74 offen lds
    s_add_u32 m0, m0, 1024
    s_add_u32 s74, s74, 8192
    buffer_load_dwordx4 v7, s[36:39], s74 offen lds
    s_waitcnt vmcnt(8)
    ds_read_b64_tr_b16 v[224:225], v11 offset:0
    ds_read_b64_tr_b16 v[226:227], v11 offset:2048
    ds_read_b64_tr_b16 v[228:229], v12 offset:0
    ds_read_b64_tr_b16 v[230:231], v12 offset:2048
    ds_read_b64_tr_b16 v[232:233], v11 offset:1024
    ds_read_b64_tr_b16 v[234:235], v11 offset:3072
    ds_read_b64_tr_b16 v[236:237], v12 offset:1024
    ds_read_b64_tr_b16 v[238:239], v12 offset:3072
    s_waitcnt lgkmcnt(0)
    v_readlane_b32 s74, v10, 9
    s_add_u32 m0, s57, 98304
    s_lshl_b32 s74, s74, 3
    s_nop 2
    buffer_load_dwordx4 v7, s[36:39], s74 offen lds
    s_add_u32 m0, m0, 1024
    s_add_u32 s74, s74, 8192
    buffer_load_dwordx4 v7, s[36:39], s74 offen lds
    s_add_u32 m0, m0, 1024
    s_add_u32 s74, s74, 8192
    buffer_load_dwordx4 v7, s[36:39], s74 offen lds
    s_add_u32 m0, m0, 1024
    s_add_u32 s74, s74, 8192
    buffer_load_dwordx4 v7, s[36:39], s74 offen lds
    s_waitcnt vmcnt(8)
    ds_read_b64_tr_b16 v[240:241], v11 offset:4096
    ds_read_b64_tr_b16 v[242:243], v11 offset:6144
    ds_read_b64_tr_b16 v[244:245], v12 offset:4096
    ds_read_b64_tr_b16 v[246:247], v12 offset:6144
    ds_read_b64_tr_b16 v[248:249], v11 offset:5120
    ds_read_b64_tr_b16 v[250:251], v11 offset:7168
    ds_read_b64_tr_b16 v[252:253], v12 offset:5120
    ds_read_b64_tr_b16 v[254:255], v12 offset:7168
    s_waitcnt lgkmcnt(0)
    v_readlane_b32 s74, v10, 10
    s_add_u32 m0, s57, 102400
    s_lshl_b32 s74, s74, 3
    s_nop 2
    buffer_load_dwordx4 v7, s[36:39], s74 offen lds
    s_add_u32 m0, m0, 1024
    s_add_u32 s74, s74, 8192
    buffer_load_dwordx4 v7, s[36:39], s74 offen lds
    s_add_u32 m0, m0, 1024
    s_add_u32 s74, s74, 8192
    buffer_load_dwordx4 v7, s[36:39], s74 offen lds
    s_add_u32 m0, m0, 1024
    s_add_u32 s74, s74, 8192
    buffer_load_dwordx4 v7, s[36:39], s74 offen lds
    s_mov_b32 s77, 3
L_wf2:
    ds_read_b128 v[32:35], v25
    s_waitcnt lgkmcnt(0)
    v_min3_u32 v32, v32, v33, v34
    v_min_u32 v32, v32, v35
    s_nop 0
    v_readfirstlane_b32 s74, v32
    s_nop 0
    s_add_u32 s74, s74, 2
    s_cmp_ge_u32 s74, s77
    s_cbranch_scc1 L_wf2ok
    s_sleep 1
    s_branch L_wf2
L_wf2ok:
    s_lshr_b32 s76, s72, 1
    s_add_u32 s76, s76, 1
    s_bitcmp0_b32 s76, 1
    s_cselect_b64 s[40:41], s[52:53], s[54:55]
    s_and_b32 s74, s76, 1
    s_lshl_b32 s74, s74, 7
    s_lshl_b32 s75, s69, 8
    s_add_u32 s74, s74, s75
    s_add_u32 m0, s57, 49152
    s_nop 0
    buffer_load_dwordx4 v8, s[40:43], s74 offen lds
    s_add_u32 m0, m0, 1024
    s_add_u32 s74, s74, 8192
    buffer_load_dwordx4 v9, s[40:43], s74 offen lds
    s_add_u32 m0, m0, 1024
    s_add_u32 s74, s74, 8192
    buffer_load_dwordx4 v8, s[40:43], s74 offen lds
    s_add_u32 m0, m0, 1024
    s_add_u32 s74, s74, 8192
    buffer_load_dwordx4 v9, s[40:43], s74 offen lds
    s_add_u32 m0, m0, 1024
    s_add_u32 s74, s74, 8192
    buffer_load_dwordx4 v8, s[40:43], s74 offen lds
    s_add_u32 m0, m0, 1024
    s_add_u32 s74, s74, 8192
    buffer_load_dwordx4 v9, s[40:43], s74 offen lds
    s_add_u32 m0, m0, 1024
    s_add_u32 s74, s74, 8192
    buffer_load_dwordx4 v8, s[40:43], s74 offen lds
    s_add_u32 m0, m0, 1024
    s_add_u32 s74, s74, 8192
    buffer_load_dwordx4 v9, s[40:43], s74 offen lds
    s_lshr_b32 s76, s72, 1
    s_add_u32 s76, s76, 2
    s_bitcmp0_b32 s76, 1
    s_cselect_b64 s[40:41], s[52:53], s[54:55]
    s_and_b32 s74, s76, 1
    s_lshl_b32 s74, s74, 7
    s_lshl_b32 s75, s69, 8
    s_add_u32 s74, s74, s75
    s_add_u32 s74, s74, 32768
    s_add_u32 m0, s57, 57344
    s_nop 0
    buffer_load_dwordx4 v8, s[40:43], s74 offen lds
    s_add_u32 m0, m0, 1024
    s_add_u32 s74, s74, 8192
    buffer_load_dwordx4 v9, s[40:43], s74 offen lds
    s_add_u32 m0, m0, 1024
    s_add_u32 s74, s74, 8192
    buffer_load_dwordx4 v8, s[40:43], s74 offen lds
    s_add_u32 m0, m0, 1024
    s_add_u32 s74, s74, 8192
    buffer_load_dwordx4 v9, s[40:43], s74 offen lds
    s_lshr_b32 s76, s72, 1
    s_add_u32 s76, s76, 0
    s_bitcmp0_b32 s76, 1
    s_cselect_b64 s[40:41], s[52:53], s[54:55]
    s_and_b32 s74, s76, 1
    s_lshl_b32 s74, s74, 7
    s_lshl_b32 s75, s69, 8
    s_add_u32 s74, s74, s75
    s_add_u32 m0, s57, 0
    s_nop 0
    buffer_load_dwordx4 v8, s[40:43], s74 offen lds
    s_add_u32 m0, m0, 1024
    s_add_u32 s74, s74, 8192
    buffer_load_dwordx4 v9, s[40:43], s74 offen lds
    s_add_u32 m0, m0, 1024
    s_add_u32 s74, s74, 8192
    buffer_load_dwordx4 v8, s[40:43], s74 offen lds
    s_add_u32 m0, m0, 1024
    s_add_u32 s74, s74, 8192
    buffer_load_dwordx4 v9, s[40:43], s74 offen lds
    s_add_u32 m0, m0, 1024
    s_add_u32 s74, s74, 8192
    buffer_load_dwordx4 v8, s[40:43], s74 offen lds
    s_add_u32 m0, m0, 1024
    s_add_u32 s74, s74, 8192
    buffer_load_dwordx4 v9, s[40:43], s74 offen lds
    s_add_u32 m0, m0, 1024
    s_add_u32 s74, s74, 8192
    buffer_load_dwordx4 v8, s[40:43], s74 offen lds
    s_add_u32 m0, m0, 1024
    s_add_u32 s74, s74, 8192
    buffer_load_dwordx4 v9, s[40:43], s74 offen lds
    s_mov_b64 exec, 0xcc
    buffer_load_dwordx4 v[2:5], v14, s[24:27], s48 offen sc1
    s_mov_b64 exec, -1
    s_lshr_b32 s76, s72, 1
    s_add_u32 s76, s76, 2
    s_bitcmp0_b32 s76, 1
    s_cselect_b64 s[40:41], s[52:53], s[54:55]
    s_and_b32 s74, s76, 1
    s_lshl_b32 s74, s74, 7
    s_lshl_b32 s75, s69, 8
    s_add_u32 s74, s74, s75
    s_add_u32 m0, s57, 8192
    s_nop 0
    buffer_load_dwordx4 v8, s[40:43], s74 offen lds
    s_add_u32 m0, m0, 1024
    s_add_u32 s74, s74, 8192
    buffer_load_dwordx4 v9, s[40:43], s74 offen lds
    s_add_u32 m0, m0, 1024
    s_add_u32 s74, s74, 8192
    buffer_load_dwordx4 v8, s[40:43], s74 offen lds
    s_add_u32 m0, m0, 1024
    s_add_u32 s74, s74, 8192
    buffer_load_dwordx4 v9, s[40:43], s74 offen lds
    s_add_u32 s3, s3, 16
    s_mov_b32 m0, s3
    s_mov_b64 exec, 1
    global_load_lds_dword v30, s[62:63]
    s_mov_b64 exec, -1
    s_waitcnt vmcnt(5)
    s_mov_b64 exec, 0xcc
    s_branch L_f1c
L_f1:
    buffer_load_dwordx4 v[2:5], v14, s[24:27], s48 offen sc1
    s_waitcnt vmcnt(0)
L_f1c:
    v_cmp_ne_u64 vcc, s[60:61], v[2:3]
    s_add_u32 s79, s79, 1
    s_cbranch_vccz L_f1k
    s_cmp_lt_u32 s79, 2097152
    s_cbranch_scc1 L_f1
L_f1k:
    ds_write_b64 v6, v[4:5]
    s_mov_b64 exec, -1
    buffer_load_dwordx4 v[16:19], v13, s[32:35], s8 offen offset:0 sc1
    buffer_load_dwordx4 v[20:23], v13, s[32:35], s8 offen offset:1024 sc1
    buffer_load_dwordx4 v[24:27], v13, s[32:35], s8 offen offset:2048 sc1
    buffer_load_dwordx4 v[28:31], v13, s[32:35], s8 offen offset:3072 sc1
    s_mov_b64 exec, 0xcc00
    buffer_load_dwordx4 v[2:5], v14, s[24:27], s48 offen sc1
    s_mov_b64 exec, -1
    buffer_load_dwordx4 v[32:35], v13, s[32:35], s9 offen offset:0 sc1
    buffer_load_dwordx4 v[36:39], v13, s[32:35], s9 offen offset:1024 sc1
    buffer_load_dwordx4 v[40:43], v13, s[32:35], s9 offen offset:2048 sc1
    buffer_load_dwordx4 v[44:47], v13, s[32:35], s9 offen offset:3072 sc1
    buffer_load_dwordx4 v[48:51], v13, s[32:35], s10 offen offset:0 sc1
    buffer_load_dwordx4 v[52:55], v13, s[32:35], s10 offen offset:1024 sc1
    buffer_load_dwordx4 v[56:59], v13, s[32:35], s10 offen offset:2048 sc1
    buffer_load_dwordx4 v[60:63], v13, s[32:35], s10 offen offset:3072 sc1
    s_waitcnt vmcnt(11)
    v_mfma_f32_32x32x16_bf16 v[64:79], v[16:19], v[128:131], 0
    v_mfma_f32_32x32x16_bf16 v[80:95], v[16:19], v[132:135], 0
    v_mfma_f32_32x32x16_bf16 v[96:111], v[20:23], v[128:131], 0
    s_waitcnt vmcnt(8)
    s_mov_b64 exec, 0xcc00
    s_branch L_f2c
L_f2:
    buffer_load_dwordx4 v[2:5], v14, s[24:27], s48 offen sc1
    s_waitcnt vmcnt(0)
L_f2c:
    v_cmp_ne_u64 vcc, s[60:61], v[2:3]
    s_add_u32 s79, s79, 1
    s_cbranch_vccz L_f2k
    s_cmp_lt_u32 s79, 2097152
    s_cbranch_scc1 L_f2
L_f2k:
    ds_write_b64 v6, v[4:5]
    s_mov_b64 exec, -1
    buffer_load_dwordx4 v[16:19], v13, s[32:35], s11 offen offset:0 sc1
    v_mfma_f32_32x32x16_bf16 v[112:127], v[20:23], v[132:135], 0
    v_mfma_f32_32x32x16_bf16 v[64:79], v[24:27], v[136:139], v[64:79]
    buffer_load_dwordx4 v[20:23], v13, s[32:35], s11 offen offset:1024 sc1
    v_mfma_f32_32x32x16_bf16 v[80:95], v[24:27], v[140:143], v[80:95]
    buffer_load_dwordx4 v[128:131], v13, s[32:35], s11 offen offset:2048 sc1
    v_mfma_f32_32x32x16_bf16 v[96:111], v[28:31], v[136:139], v[96:111]
    buffer_load_dwordx4 v[132:135], v13, s[32:35], s11 offen offset:3072 sc1
    v_mfma_f32_32x32x16_bf16 v[112:127], v[28:31], v[140:143], v[112:127]
    s_waitcnt vmcnt(10)
    v_mfma_f32_32x32x16_bf16 v[64:79], v[32:35], v[144:147], v[64:79]
    s_mov_b64 exec, 0x1111
    buffer_load_dwordx2 v[2:3], v14, s[24:27], s48 offen sc1
    s_mov_b64 exec, -1
    buffer_load_dwordx4 v[24:27], v13, s[32:35], s12 offen offset:0 sc1
    v_mfma_f32_32x32x16_bf16 v[80:95], v[32:35], v[148:151], v[80:95]
    buffer_load_dwordx4 v[28:31], v13, s[32:35], s12 offen offset:1024 sc1
    v_mfma_f32_32x32x16_bf16 v[96:111], v[36:39], v[144:147], v[96:111]
    v_mfma_f32_32x32x16_bf16 v[112:127], v[36:39], v[148:151], v[112:127]
    s_waitcnt vmcnt(11)
    v_mfma_f32_32x32x16_bf16 v[64:79], v[40:43], v[152:155], v[64:79]
    buffer_load_dwordx4 v[136:139], v13, s[32:35], s12 offen offset:2048 sc1
    v_mfma_f32_32x32x16_bf16 v[80:95], v[40:43], v[156:159], v[80:95]
    buffer_load_dwordx4 v[140:143], v13, s[32:35], s12 offen offset:3072 sc1
    v_mfma_f32_32x32x16_bf16 v[96:111], v[44:47], v[152:155], v[96:111]
    v_mfma_f32_32x32x16_bf16 v[112:127], v[44:47], v[156:159], v[112:127]
    s_waitcnt vmcnt(11)
    v_mfma_f32_32x32x16_bf16 v[64:79], v[48:51], v[160:163], v[64:79]
    buffer_load_dwordx4 v[32:35], v13, s[32:35], s13 offen offset:0 sc1
    v_mfma_f32_32x32x16_bf16 v[80:95], v[48:51], v[164:167], v[80:95]
    buffer_load_dwordx4 v[36:39], v13, s[32:35], s13 offen offset:1024 sc1
    v_mfma_f32_32x32x16_bf16 v[96:111], v[52:55], v[160:163], v[96:111]
    v_mfma_f32_32x32x16_bf16 v[112:127], v[52:55], v[164:167], v[112:127]
    s_waitcnt vmcnt(11)
    v_mfma_f32_32x32x16_bf16 v[64:79], v[56:59], v[168:171], v[64:79]
    buffer_load_dwordx4 v[144:147], v13, s[32:35], s13 offen offset:2048 sc1
    v_mfma_f32_32x32x16_bf16 v[80:95], v[56:59], v[172:175], v[80:95]
    buffer_load_dwordx4 v[148:151], v13, s[32:35], s13 offen offset:3072 sc1
    v_mfma_f32_32x32x16_bf16 v[96:111], v[60:63], v[168:171], v[96:111]
    v_mfma_f32_32x32x16_bf16 v[112:127], v[60:63], v[172:175], v[112:127]
    s_waitcnt vmcnt(11)
    v_mfma_f32_32x32x16_bf16 v[64:79], v[16:19], v[176:179], v[64:79]
    buffer_load_dwordx4 v[40:43], v13, s[32:35], s14 offen offset:0 sc1
    v_mfma_f32_32x32x16_bf16 v[80:95], v[16:19], v[180:183], v[80:95]
    buffer_load_dwordx4 v[44:47], v13, s[32:35], s14 offen offset:1024 sc1
    v_mfma_f32_32x32x16_bf16 v[96:111], v[20:23], v[176:179], v[96:111]
    v_mfma_f32_32x32x16_bf16 v[112:127], v[20:23], v[180:183], v[112:127]
    s_waitcnt vmcnt(11)
    v_mfma_f32_32x32x16_bf16 v[64:79], v[128:131], v[184:187], v[64:79]
    buffer_load_dwordx4 v[152:155], v13, s[32:35], s14 offen offset:2048 sc1
    v_mfma_f32_32x32x16_bf16 v[80:95], v[128:131], v[188:191], v[80:95]
    buffer_load_dwordx4 v[156:159], v13, s[32:35], s14 offen offset:3072 sc1
    v_mfma_f32_32x32x16_bf16 v[96:111], v[132:135], v[184:187], v[96:111]
    v_mfma_f32_32x32x16_bf16 v[112:127], v[132:135], v[188:191], v[112:127]
    s_waitcnt vmcnt(10)
    v_mfma_f32_32x32x16_bf16 v[64:79], v[24:27], v[192:195], v[64:79]
    s_mov_b64 exec, 0x1111
    s_branch L_f0c
L_f0:
    buffer_load_dwordx2 v[2:3], v14, s[24:27], s48 offen sc1
    s_waitcnt vmcnt(0)
L_f0c:
    v_cmp_ne_u64 vcc, s[60:61], v[2:3]
    s_add_u32 s79, s79, 1
    s_cbranch_vccz L_f0k
    s_cmp_lt_u32 s79, 2097152
    s_cbranch_scc1 L_f0
L_f0k:
    s_mov_b64 exec, -1
    buffer_load_dwordx4 v[48:51], v13, s[32:35], s15 offen offset:0 sc1
    v_mfma_f32_32x32x16_bf16 v[80:95], v[24:27], v[196:199], v[80:95]
    buffer_load_dwordx4 v[52:55], v13, s[32:35], s15 offen offset:1024 sc1
    v_mfma_f32_32x32x16_bf16 v[96:111], v[28:31], v[192:195], v[96:111]
    v_mfma_f32_32x32x16_bf16 v[112:127], v[28:31], v[196:199], v[112:127]
    ds_read_b64_tr_b16 v[192:193], v11 offset:8192
    ds_read_b64_tr_b16 v[194:195], v11 offset:10240
    ds_read_b64_tr_b16 v[196:197], v12 offset:8192
    ds_read_b64_tr_b16 v[198:199], v12 offset:10240
    s_waitcnt vmcnt(10)
    v_mfma_f32_32x32x16_bf16 v[64:79], v[136:139], v[200:203], v[64:79]
    buffer_load_dwordx4 v[160:163], v13, s[32:35], s15 offen offset:2048 sc1
    v_mfma_f32_32x32x16_bf16 v[80:95], v[136:139], v[204:207], v[80:95]
    buffer_load_dwordx4 v[164:167], v13, s[32:35], s15 offen offset:3072 sc1
    v_mfma_f32_32x32x16_bf16 v[96:111], v[140:143], v[200:203], v[96:111]
    v_mfma_f32_32x32x16_bf16 v[112:127], v[140:143], v[204:207], v[112:127]
    ds_read_b64_tr_b16 v[200:201], v11 offset:9216
    ds_read_b64_tr_b16 v[202:203], v11 offset:11264
    ds_read_b64_tr_b16 v[204:205], v12 offset:9216
    ds_read_b64_tr_b16 v[206:207], v12 offset:11264
    s_waitcnt vmcnt(10)
    v_mfma_f32_32x32x16_bf16 v[64:79], v[32:35], v[208:211], v[64:79]
    buffer_load_dwordx4 v[56:59], v13, s[32:35], s16 offen offset:0 sc1
    v_mfma_f32_32x32x16_bf16 v[80:95], v[32:35], v[212:215], v[80:95]
    buffer_load_dwordx4 v[60:63], v13, s[32:35], s16 offen offset:1024 sc1
    v_mfma_f32_32x32x16_bf16 v[96:111], v[36:39], v[208:211], v[96:111]
    v_mfma_f32_32x32x16_bf16 v[112:127], v[36:39], v[212:215], v[112:127]
    ds_read_b64_tr_b16 v[208:209], v11 offset:0
    ds_read_b64_tr_b16 v[210:211], v11 offset:2048
    ds_read_b64_tr_b16 v[212:213], v12 offset:0
    ds_read_b64_tr_b16 v[214:215], v12 offset:2048
    s_waitcnt vmcnt(10)
    v_mfma_f32_32x32x16_bf16 v[64:79], v[144:147], v[216:219], v[64:79]
    buffer_load_dwordx4 v[168:171], v13, s[32:35], s16 offen offset:2048 sc1
    v_mfma_f32_32x32x16_bf16 v[80:95], v[144:147], v[220:223], v[80:95]
    buffer_load_dwordx4 v[172:175], v13, s[32:35], s16 offen offset:3072 sc1
    v_mfma_f32_32x32x16_bf16 v[96:111], v[148:151], v[216:219], v[96:111]
    v_mfma_f32_32x32x16_bf16 v[112:127], v[148:151], v[220:223], v[112:127]
    ds_read_b64_tr_b16 v[216:217], v11 offset:1024
    ds_read_b64_tr_b16 v[218:219], v11 offset:3072
    ds_read_b64_tr_b16 v[220:221], v12 offset:1024
    ds_read_b64_tr_b16 v[222:223], v12 offset:3072
    s_waitcnt vmcnt(10)
    v_mfma_f32_32x32x16_bf16 v[64:79], v[40:43], v[224:227], v[64:79]
    buffer_load_dwordx4 v[16:19], v13, s[32:35], s17 offen offset:0 sc1
    v_mfma_f32_32x32x16_bf16 v[80:95], v[40:43], v[228:231], v[80:95]
    buffer_load_dwordx4 v[20:23], v13, s[32:35], s17 offen offset:1024 sc1
    v_mfma_f32_32x32x16_bf16 v[96:111], v[44:47], v[224:227], v[96:111]
    v_mfma_f32_32x32x16_bf16 v[112:127], v[44:47], v[228:231], v[112:127]
    ds_read_b64_tr_b16 v[224:225], v11 offset:4096
    ds_read_b64_tr_b16 v[226:227], v11 offset:6144
    ds_read_b64_tr_b16 v[228:229], v12 offset:4096
    ds_read_b64_tr_b16 v[230:231], v12 offset:6144
    s_waitcnt vmcnt(10)
    v_mfma_f32_32x32x16_bf16 v[64:79], v[152:155], v[232:235], v[64:79]
    buffer_load_dwordx4 v[176:179], v13, s[32:35], s17 offen offset:2048 sc1
    v_mfma_f32_32x32x16_bf16 v[80:95], v[152:155], v[236:239], v[80:95]
    buffer_load_dwordx4 v[180:183], v13, s[32:35], s17 offen offset:3072 sc1
    v_mfma_f32_32x32x16_bf16 v[96:111], v[156:159], v[232:235], v[96:111]
    v_mfma_f32_32x32x16_bf16 v[112:127], v[156:159], v[236:239], v[112:127]
    ds_read_b64_tr_b16 v[232:233], v11 offset:5120
    ds_read_b64_tr_b16 v[234:235], v11 offset:7168
    ds_read_b64_tr_b16 v[236:237], v12 offset:5120
    ds_read_b64_tr_b16 v[238:239], v12 offset:7168
    s_waitcnt vmcnt(10)
    v_mfma_f32_32x32x16_bf16 v[64:79], v[48:51], v[240:243], v[64:79]
    buffer_load_dwordx4 v[128:131], v13, s[32:35], s18 offen offset:0 sc1
    v_mfma_f32_32x32x16_bf16 v[80:95], v[48:51], v[244:247], v[80:95]
    buffer_load_dwordx4 v[132:135], v13, s[32:35], s18 offen offset:1024 sc1
    v_mfma_f32_32x32x16_bf16 v[96:111], v[52:55], v[240:243], v[96:111]
    v_mfma_f32_32x32x16_bf16 v[112:127], v[52:55], v[244:247], v[112:127]
    s_waitcnt vmcnt(10)
    v_mfma_f32_32x32x16_bf16 v[64:79], v[160:163], v[248:251], v[64:79]
    buffer_load_dwordx4 v[184:187], v13, s[32:35], s18 offen offset:2048 sc1
    v_mfma_f32_32x32x16_bf16 v[80:95], v[160:163], v[252:255], v[80:95]
    buffer_load_dwordx4 v[188:191], v13, s[32:35], s18 offen offset:3072 sc1
    v_mfma_f32_32x32x16_bf16 v[96:111], v[164:167], v[248:251], v[96:111]
    v_mfma_f32_32x32x16_bf16 v[112:127], v[164:167], v[252:255], v[112:127]
    s_waitcnt vmcnt(10) lgkmcnt(0)
    v_mfma_f32_32x32x16_bf16 v[64:79], v[56:59], v[192:195], v[64:79]
    v_mfma_f32_32x32x16_bf16 v[80:95], v[56:59], v[196:199], v[80:95]
    v_mfma_f32_32x32x16_bf16 v[96:111], v[60:63], v[192:195], v[96:111]
    v_mfma_f32_32x32x16_bf16 v[112:127], v[60:63], v[196:199], v[112:127]
    s_waitcnt vmcnt(8)
    v_mfma_f32_32x32x16_bf16 v[64:79], v[168:171], v[200:203], v[64:79]
    v_mfma_f32_32x32x16_bf16 v[80:95], v[168:171], v[204:207], v[80:95]
    v_mfma_f32_32x32x16_bf16 v[96:111], v[172:175], v[200:203], v[96:111]
    v_mfma_f32_32x32x16_bf16 v[112:127], v[172:175], v[204:207], v[112:127]
    s_waitcnt vmcnt(6)
    v_mfma_f32_32x32x16_bf16 v[64:79], v[16:19], v[208:211], v[64:79]
    v_mfma_f32_32x32x16_bf16 v[80:95], v[16:19], v[212:215], v[80:95]
    v_mfma_f32_32x32x16_bf16 v[96:111], v[20:23], v[208:211], v[96:111]
    v_mfma_f32_32x32x16_bf16 v[112:127], v[20:23], v[212:215], v[112:127]
    s_waitcnt vmcnt(4)
    v_mfma_f32_32x32x16_bf16 v[64:79], v[176:179], v[216:219], v[64:79]
    v_mfma_f32_32x32x16_bf16 v[80:95], v[176:179], v[220:223], v[80:95]
    v_mfma_f32_32x32x16_bf16 v[96:111], v[180:183], v[216:219], v[96:111]
    v_mfma_f32_32x32x16_bf16 v[112:127], v[180:183], v[220:223], v[112:127]
    s_waitcnt vmcnt(2)
    v_mfma_f32_32x32x16_bf16 v[64:79], v[128:131], v[224:227], v[64:79]
    v_mfma_f32_32x32x16_bf16 v[80:95], v[128:131], v[228:231], v[80:95]
    v_mfma_f32_32x32x16_bf16 v[96:111], v[132:135], v[224:227], v[96:111]
    v_mfma_f32_32x32x16_bf16 v[112:127], v[132:135], v[228:231], v[112:127]
    s_waitcnt vmcnt(0)
    v_mfma_f32_32x32x16_bf16 v[64:79], v[184:187], v[232:235], v[64:79]
    v_mfma_f32_32x32x16_bf16 v[80:95], v[184:187], v[236:239], v[80:95]
    v_mfma_f32_32x32x16_bf16 v[96:111], v[188:191], v[232:235], v[96:111]
    v_mfma_f32_32x32x16_bf16 v[112:127], v[188:191], v[236:239], v[112:127]
    s_lshl_b32 s74, s69, 2
    s_add_u32 s74, s74, 150176
    v_mov_b32 v16, s74
L_pw:
    ds_read_b32 v17, v16
    s_waitcnt lgkmcnt(0)
    v_cmp_gt_u32 vcc, 10, v17
    s_cbranch_vccnz L_pw
    v_bfe_u32 v4, v1, 4, 1
    v_lshrrev_b32 v5, 5, v1
    v_lshl_add_u32 v2, v4, 4, v5
    s_and_b32 s74, s69, 1
    s_lshl_b32 s74, s74, 5
    s_and_b32 s75, s69, 2
    s_lshl1_add_u32 s74, s75, s74
    v_add_u32 v2, s74, v2
    v_and_b32 v3, 15, v1
    s_lshl_b32 s74, s71, 7
    v_lshl_add_u32 v6, v3, 3, s74
    v_lshl_add_u32 v8, v2, 10, v6
    s_lshl_b32 s75, s70, 16
    s_add_u32 s76, s75, 8192
    buffer_load_dwordx2 v[16:17], v8, s[4:7], s75 offen offset:0
    buffer_load_dwordx2 v[18:19], v8, s[4:7], s75 offen offset:2048
    buffer_load_dwordx2 v[20:21], v8, s[4:7], s76 offen offset:0
    buffer_load_dwordx2 v[22:23], v8, s[4:7], s76 offen offset:2048
    global_load_dwordx2 v[24:25], v6, s[58:59]
    s_add_u32 s48, s57, 98304
    s_add_u32 s50, s57, 8192
    v_lshl_add_u32 v10, v1, 2, s48
    v_lshl_add_u32 v12, v1, 2, s50
    ds_write2st64_b32 v10, v64, v65 offset0:0 offset1:1
    ds_write2st64_b32 v10, v66, v67 offset0:2 offset1:3
    ds_write2st64_b32 v10, v68, v69 offset0:4 offset1:5
    ds_write2st64_b32 v10, v70, v71 offset0:6 offset1:7
    ds_write2st64_b32 v10, v72, v73 offset0:8 offset1:9
    ds_write2st64_b32 v10, v74, v75 offset0:10 offset1:11
    ds_write2st64_b32 v10, v76, v77 offset0:12 offset1:13
    ds_write2st64_b32 v10, v78, v79 offset0:14 offset1:15
    ds_write2st64_b32 v10, v80, v81 offset0:16 offset1:17
    ds_write2st64_b32 v10, v82, v83 offset0:18 offset1:19
    ds_write2st64_b32 v10, v84, v85 offset0:20 offset1:21
    ds_write2st64_b32 v10, v86, v87 offset0:22 offset1:23
    ds_write2st64_b32 v10, v88, v89 offset0:24 offset1:25
    ds_write2st64_b32 v10, v90, v91 offset0:26 offset1:27
    ds_write2st64_b32 v10, v92, v93 offset0:28 offset1:29
    ds_write2st64_b32 v10, v94, v95 offset0:30 offset1:31
    ds_write2st64_b32 v10, v96, v97 offset0:32 offset1:33
    ds_write2st64_b32 v10, v98, v99 offset0:34 offset1:35
    ds_write2st64_b32 v10, v100, v101 offset0:36 offset1:37
    ds_write2st64_b32 v10, v102, v103 offset0:38 offset1:39
    ds_write2st64_b32 v10, v104, v105 offset0:40 offset1:41
    ds_write2st64_b32 v10, v106, v107 offset0:42 offset1:43
    ds_write2st64_b32 v10, v108, v109 offset0:44 offset1:45
    ds_write2st64_b32 v10, v110, v111 offset0:46 offset1:47
    ds_write2st64_b32 v12, v112, v113 offset0:0 offset1:1
    ds_write2st64_b32 v12, v114, v115 offset0:2 offset1:3
    ds_write2st64_b32 v12, v116, v117 offset0:4 offset1:5
    ds_write2st64_b32 v12, v118, v119 offset0:6 offset1:7
    ds_write2st64_b32 v12, v120, v121 offset0:8 offset1:9
    ds_write2st64_b32 v12, v122, v123 offset0:10 offset1:11
    ds_write2st64_b32 v12, v124, v125 offset0:12 offset1:13
    ds_write2st64_b32 v12, v126, v127 offset0:14 offset1:15
    s_lshl2_add_u32 s74, s69, 150192
    v_mov_b32 v11, s74
    v_mov_b32 v13, 0
    ds_write_b32 v11, v13
    v_lshlrev_b32 v9, 2, v2
    v_add_u32 v9, 149568, v9
    v_lshlrev_b32 v5, 8, v5
    v_lshl_add_u32 v5, v4, 7, v5
    v_and_b32 v4, 7, v1
    v_lshl_add_u32 v5, v4, 4, v5
    s_lshl_b32 s74, s69, 10
    v_add_u32 v5, s74, v5
    v_bfe_u32 v7, v1, 3, 1
    v_lshl_add_u32 v4, v7, 12, v5
    v_add_u32 v3, 49152, v4
    v_add_u32 v14, 98304, v4
    v_mul_u32_u24 v7, 98304, v7
    v_add_u32 v15, 106496, v5
    v_sub_u32 v15, v15, v7
    v_lshlrev_b32 v8, 1, v8
    v_mov_b32 v11, 150192
    s_waitcnt vmcnt(0)
    v_lshlrev_b32 v32, 16, v24
    v_and_b32 v33, 0xffff0000, v24
    v_lshlrev_b32 v34, 16, v25
    v_and_b32 v35, 0xffff0000, v25
    v_lshlrev_b32 v40, 16, v16
    v_and_b32 v41, 0xffff0000, v16
    v_lshlrev_b32 v42, 16, v17
    v_and_b32 v43, 0xffff0000, v17
    v_mul_f32 v40, v40, v32
    v_mul_f32 v41, v41, v33
    v_cvt_pk_bf16_f32 v41, v40, v41
    v_lshlrev_b32 v40, 16, v41
    v_and_b32 v41, 0xffff0000, v41
    v_mul_f32 v42, v42, v34
    v_mul_f32 v43, v43, v35
    v_cvt_pk_bf16_f32 v43, v42, v43
    v_lshlrev_b32 v42, 16, v43
    v_and_b32 v43, 0xffff0000, v43
    v_lshlrev_b32 v44, 16, v18
    v_and_b32 v45, 0xffff0000, v18
    v_lshlrev_b32 v46, 16, v19
    v_and_b32 v47, 0xffff0000, v19
    v_mul_f32 v44, v44, v32
    v_mul_f32 v45, v45, v33
    v_cvt_pk_bf16_f32 v45, v44, v45
    v_lshlrev_b32 v44, 16, v45
    v_and_b32 v45, 0xffff0000, v45
    v_mul_f32 v46, v46, v34
    v_mul_f32 v47, v47, v35
    v_cvt_pk_bf16_f32 v47, v46, v47
    v_lshlrev_b32 v46, 16, v47
    v_and_b32 v47, 0xffff0000, v47
    v_lshlrev_b32 v48, 16, v20
    v_and_b32 v49, 0xffff0000, v20
    v_lshlrev_b32 v50, 16, v21
    v_and_b32 v51, 0xffff0000, v21
    v_mul_f32 v48, v48, v32
    v_mul_f32 v49, v49, v33
    v_cvt_pk_bf16_f32 v49, v48, v49
    v_lshlrev_b32 v48, 16, v49
    v_and_b32 v49, 0xffff0000, v49
    v_mul_f32 v50, v50, v34
    v_mul_f32 v51, v51, v35
    v_cvt_pk_bf16_f32 v51, v50, v51
    v_lshlrev_b32 v50, 16, v51
    v_and_b32 v51, 0xffff0000, v51
    v_lshlrev_b32 v52, 16, v22
    v_and_b32 v53, 0xffff0000, v22
    v_lshlrev_b32 v54, 16, v23
    v_and_b32 v55, 0xffff0000, v23
    v_mul_f32 v52, v52, v32
    v_mul_f32 v53, v53, v33
    v_cvt_pk_bf16_f32 v53, v52, v53
    v_lshlrev_b32 v52, 16, v53
    v_and_b32 v53, 0xffff0000, v53
    v_mul_f32 v54, v54, v34
    v_mul_f32 v55, v55, v35
    v_cvt_pk_bf16_f32 v55, v54, v55
    v_lshlrev_b32 v54, 16, v55
    v_and_b32 v55, 0xffff0000, v55
L_ld:
    ds_read_b128 v[60:63], v11
    s_waitcnt lgkmcnt(0)
    v_or3_b32 v60, v60, v61, v62
    v_or_b32 v60, v60, v63
    v_cmp_eq_u32 vcc, 0, v60
    s_cbranch_vccz L_ld
    ds_read2_b32 v[28:29], v9 offset1:2
    ds_read2_b32 v[30:31], v9 offset0:8 offset1:10
    ds_read_b128 v[128:131], v14 offset:0
    ds_read_b128 v[132:135], v14 offset:12288
    ds_read_b128 v[136:139], v14 offset:24576
    ds_read_b128 v[140:143], v14 offset:36864
    ds_read_b128 v[144:147], v14 offset:512
    ds_read_b128 v[148:151], v14 offset:12800
    ds_read_b128 v[152:155], v14 offset:25088
    ds_read_b128 v[156:159], v14 offset:37376
    ds_read_b128 v[160:163], v15 offset:0
    ds_read_b128 v[164:167], v15 offset:12288
    ds_read_b128 v[168:171], v15 offset:24576
    ds_read_b128 v[172:175], v15 offset:36864
    ds_read_b128 v[176:179], v15 offset:512
    ds_read_b128 v[180:183], v15 offset:12800
    ds_read_b128 v[184:187], v15 offset:25088
    ds_read_b128 v[188:191], v15 offset:37376
    s_waitcnt lgkmcnt(12)
    v_add_f32 v128, v128, v132
    v_add_f32 v129, v129, v133
    v_add_f32 v130, v130, v134
    v_add_f32 v131, v131, v135
    v_add_f32 v128, v128, v136
    v_add_f32 v129, v129, v137
    v_add_f32 v130, v130, v138
    v_add_f32 v131, v131, v139
    v_add_f32 v128, v128, v140
    v_add_f32 v129, v129, v141
    v_add_f32 v130, v130, v142
    v_add_f32 v131, v131, v143
    v_sub_f32 v36, 1.0, v28
    v_sub_f32 v37, 1.0, v29
    v_cvt_pk_bf16_f32 v37, v36, v37
    v_lshlrev_b32 v36, 16, v37
    v_and_b32 v37, 0xffff0000, v37
    v_mul_f32 v40, v40, v28
    v_mul_f32 v41, v41, v28
    v_mul_f32 v42, v42, v28
    v_mul_f32 v43, v43, v28
    v_fmac_f32 v40, v128, v36
    v_fmac_f32 v41, v129, v36
    v_fmac_f32 v42, v130, v36
    v_fmac_f32 v43, v131, v36
    s_waitcnt lgkmcnt(8)
    v_add_f32 v144, v144, v148
    v_add_f32 v145, v145, v149
    v_add_f32 v146, v146, v150
    v_add_f32 v147, v147, v151
    v_add_f32 v144, v144, v152
    v_add_f32 v145, v145, v153
    v_add_f32 v146, v146, v154
    v_add_f32 v147, v147, v155
    v_add_f32 v144, v144, v156
    v_add_f32 v145, v145, v157
    v_add_f32 v146, v146, v158
    v_add_f32 v147, v147, v159
    v_mul_f32 v44, v44, v29
    v_mul_f32 v45, v45, v29
    v_mul_f32 v46, v46, v29
    v_mul_f32 v47, v47, v29
    v_fmac_f32 v44, v144, v37
    v_fmac_f32 v45, v145, v37
    v_fmac_f32 v46, v146, v37
    v_fmac_f32 v47, v147, v37
    s_waitcnt lgkmcnt(4)
    v_add_f32 v160, v160, v164
    v_add_f32 v161, v161, v165
    v_add_f32 v162, v162, v166
    v_add_f32 v163, v163, v167
    v_add_f32 v160, v160, v168
    v_add_f32 v161, v161, v169
    v_add_f32 v162, v162, v170
    v_add_f32 v163, v163, v171
    v_add_f32 v160, v160, v172
    v_add_f32 v161, v161, v173
    v_add_f32 v162, v162, v174
    v_add_f32 v163, v163, v175
    v_sub_f32 v38, 1.0, v30
    v_sub_f32 v39, 1.0, v31
    v_cvt_pk_bf16_f32 v39, v38, v39
    v_lshlrev_b32 v38, 16, v39
    v_and_b32 v39, 0xffff0000, v39
    v_mul_f32 v48, v48, v30
    v_mul_f32 v49, v49, v30
    v_mul_f32 v50, v50, v30
    v_mul_f32 v51, v51, v30
    v_fmac_f32 v48, v160, v38
    v_fmac_f32 v49, v161, v38
    v_fmac_f32 v50, v162, v38
    v_fmac_f32 v51, v163, v38
    s_waitcnt lgkmcnt(0)
    v_add_f32 v176, v176, v180
    v_add_f32 v177, v177, v181
    v_add_f32 v178, v178, v182
    v_add_f32 v179, v179, v183
    v_add_f32 v176, v176, v184
    v_add_f32 v177, v177, v185
    v_add_f32 v178, v178, v186
    v_add_f32 v179, v179, v187
    v_add_f32 v176, v176, v188
    v_add_f32 v177, v177, v189
    v_add_f32 v178, v178, v190
    v_add_f32 v179, v179, v191
    v_mul_f32 v52, v52, v31
    v_mul_f32 v53, v53, v31
    v_mul_f32 v54, v54, v31
    v_mul_f32 v55, v55, v31
    v_fmac_f32 v52, v176, v39
    v_fmac_f32 v53, v177, v39
    v_fmac_f32 v54, v178, v39
    v_fmac_f32 v55, v179, v39
    v_add_f32 v28, v28, v28
    v_add_f32 v29, v29, v29
    v_add_f32 v30, v30, v30
    v_add_f32 v31, v31, v31
    s_lshl_b32 s75, s70, 17
    s_barrier
    ds_read_b128 v[128:131], v4 offset:0
    ds_read_b128 v[132:135], v4 offset:12288
    ds_read_b128 v[136:139], v4 offset:24576
    ds_read_b128 v[140:143], v4 offset:36864
    ds_read_b128 v[144:147], v4 offset:512
    ds_read_b128 v[148:151], v4 offset:12800
    ds_read_b128 v[152:155], v4 offset:25088
    ds_read_b128 v[156:159], v4 offset:37376
    ds_read_b128 v[160:163], v3 offset:0
    ds_read_b128 v[164:167], v3 offset:12288
    ds_read_b128 v[168:171], v3 offset:24576
    ds_read_b128 v[172:175], v3 offset:36864
    ds_read_b128 v[176:179], v3 offset:512
    ds_read_b128 v[180:183], v3 offset:12800
    ds_read_b128 v[184:187], v3 offset:25088
    ds_read_b128 v[188:191], v3 offset:37376
    s_waitcnt lgkmcnt(12)
    v_pk_add_f32 v[128:129], v[128:129], v[132:133]
    v_pk_add_f32 v[136:137], v[136:137], v[140:141]
    v_pk_add_f32 v[130:131], v[130:131], v[134:135]
    v_pk_add_f32 v[138:139], v[138:139], v[142:143]
    v_pk_add_f32 v[128:129], v[128:129], v[136:137]
    v_pk_add_f32 v[130:131], v[130:131], v[138:139]
    v_fmac_f32 v40, v128, v28
    v_fmac_f32 v41, v129, v28
    v_fmac_f32 v42, v130, v28
    v_fmac_f32 v43, v131, v28
    buffer_store_dwordx4 v[40:43], v8, s[44:47], s75 offen sc1
    s_add_u32 s75, s75, 4096
    s_waitcnt lgkmcnt(8)
    v_pk_add_f32 v[144:145], v[144:145], v[148:149]
    v_pk_add_f32 v[152:153], v[152:153], v[156:157]
    v_pk_add_f32 v[146:147], v[146:147], v[150:151]
    v_pk_add_f32 v[154:155], v[154:155], v[158:159]
    v_pk_add_f32 v[144:145], v[144:145], v[152:153]
    v_pk_add_f32 v[146:147], v[146:147], v[154:155]
    v_fmac_f32 v44, v144, v29
    v_fmac_f32 v45, v145, v29
    v_fmac_f32 v46, v146, v29
    v_fmac_f32 v47, v147, v29
    buffer_store_dwordx4 v[44:47], v8, s[44:47], s75 offen sc1
    s_add_u32 s75, s75, 12288
    s_waitcnt lgkmcnt(4)
    v_pk_add_f32 v[160:161], v[160:161], v[164:165]
    v_pk_add_f32 v[168:169], v[168:169], v[172:173]
    v_pk_add_f32 v[162:163], v[162:163], v[166:167]
    v_pk_add_f32 v[170:171], v[170:171], v[174:175]
    v_pk_add_f32 v[160:161], v[160:161], v[168:169]
    v_pk_add_f32 v[162:163], v[162:163], v[170:171]
    v_fmac_f32 v48, v160, v30
    v_fmac_f32 v49, v161, v30
    v_fmac_f32 v50, v162, v30
    v_fmac_f32 v51, v163, v30
    buffer_store_dwordx4 v[48:51], v8, s[44:47], s75 offen sc1
    s_add_u32 s75, s75, 4096
    s_waitcnt lgkmcnt(0)
    v_pk_add_f32 v[176:177], v[176:177], v[180:181]
    v_pk_add_f32 v[184:185], v[184:185], v[188:189]
    v_pk_add_f32 v[178:179], v[178:179], v[182:183]
    v_pk_add_f32 v[186:187], v[186:187], v[190:191]
    v_pk_add_f32 v[176:177], v[176:177], v[184:185]
    v_pk_add_f32 v[178:179], v[178:179], v[186:187]
    v_fmac_f32 v52, v176, v31
    v_fmac_f32 v53, v177, v31
    v_fmac_f32 v54, v178, v31
    v_fmac_f32 v55, v179, v31
    buffer_store_dwordx4 v[52:55], v8, s[44:47], s75 offen sc1
    s_endpgm
L_C1:
    s_lshl_b32 s48, s65, 1
    s_add_u32 s48, s48, s68
    s_lshl_b32 s48, s48, 13
    s_lshl_b32 s49, s66, 9
    s_add_u32 s48, s48, s49
    s_add_u32 s48, s48, 10747904
    s_add_u32 s48, s24, s48
    s_addc_u32 s49, s25, 0
    s_load_dword s3, s[48:49], 0
    s_load_dword s3, s[48:49], 64
    s_load_dword s3, s[48:49], 128
    s_load_dword s3, s[48:49], 192
    s_load_dword s3, s[48:49], 256
    s_load_dword s3, s[48:49], 320
    s_lshl_b32 s50, s65, 9
    s_lshl_b32 s51, s68, 8
    s_add_u32 s50, s50, s51
    s_add_u32 s50, s28, s50
    s_addc_u32 s51, s29, 0
    s_load_dword s3, s[50:51], 0
    s_load_dword s3, s[50:51], 64
    s_load_dword s3, s[50:51], 128
    s_load_dword s3, s[50:51], 192
    s_lshl_b32 s74, s66, 6
    s_load_dword s3, s[60:61], s74
    s_load_dword s3, s[58:59], s74
    s_cmp_eq_u32 s73, 2
    s_cbranch_scc0 L_heavy
    v_mov_b64 v[48:49], 0
    v_mov_b64 v[50:51], 0
    v_mov_b64 v[52:53], 0
    v_mov_b64 v[54:55], 0
    v_mov_b64 v[56:57], 0
    v_mov_b64 v[58:59], 0
    v_mov_b64 v[60:61], 0
    v_mov_b64 v[62:63], 0
    v_mov_b64 v[80:81], 0
    v_mov_b64 v[82:83], 0
    v_mov_b64 v[84:85], 0
    v_mov_b64 v[86:87], 0
    v_mov_b64 v[88:89], 0
    v_mov_b64 v[90:91], 0
    v_mov_b64 v[92:93], 0
    v_mov_b64 v[94:95], 0
    s_branch L_lt_first1
L_lt_spin1:
    ds_read_b128 v[96:99], v31
    s_waitcnt lgkmcnt(0)
    v_or3_b32 v96, v96, v97, v98
    v_or_b32 v96, v96, v99
    v_cmp_eq_u32 vcc, 0, v96
    s_cbranch_vccz L_lt_spin1
    s_branch L_lt_go1
L_lt_first1:
    ds_read_b128 v[96:99], v31
    s_waitcnt lgkmcnt(0)
    v_and_b32 v96, v96, v97
    v_cmp_eq_u32 vcc, 0, v96
    s_cbranch_vccz L_lt_first1
    global_load_dwordx2 v[100:101], v30, s[62:63] sc1
    s_branch L_lt_spin1
L_lt_Ck1:
    s_waitcnt lgkmcnt(6)
    v_mfma_f32_16x16x32_bf16 v[128:131], v[64:67], v[32:35], v[128:131]
    ds_read_b64_tr_b16 v[80:81], v6 offset:30720
    v_mfma_f32_16x16x32_bf16 v[132:135], v[64:67], v[36:39], v[132:135]
    ds_read_b64_tr_b16 v[82:83], v6 offset:30976
    v_mfma_f32_16x16x32_bf16 v[136:139], v[64:67], v[40:43], v[136:139]
    s_mov_b32 s78, 49152
    ds_read_b128 v[48:51], v3 offset:0
    v_mfma_f32_16x16x32_bf16 v[140:143], v[64:67], v[44:47], v[140:143]
    ds_read_b128 v[52:55], v3 offset:2048
    s_waitcnt lgkmcnt(8)
    v_mfma_f32_16x16x32_bf16 v[144:147], v[68:71], v[32:35], v[144:147]
    ds_read_b64_tr_b16 v[84:85], v7 offset:30720
    v_mfma_f32_16x16x32_bf16 v[148:151], v[68:71], v[36:39], v[148:151]
    ds_read_b64_tr_b16 v[86:87], v7 offset:30976
    v_mfma_f32_16x16x32_bf16 v[152:155], v[68:71], v[40:43], v[152:155]
    s_movk_i32 s74, 0x24
    ds_read_b128 v[56:59], v3 offset:4096
    v_mfma_f32_16x16x32_bf16 v[156:159], v[68:71], v[44:47], v[156:159]
    s_bitcmp1_b32 s74, s77
    s_cmov_b32 s78, 4294868992
    ds_read_b128 v[60:63], v3 offset:6144
    s_waitcnt lgkmcnt(10)
    v_mfma_f32_16x16x32_bf16 v[160:163], v[72:75], v[32:35], v[160:163]
    ds_read_b64_tr_b16 v[88:89], v6 offset:43008
    v_mfma_f32_16x16x32_bf16 v[164:167], v[72:75], v[36:39], v[164:167]
    ds_read_b64_tr_b16 v[90:91], v6 offset:43264
    v_mfma_f32_16x16x32_bf16 v[168:171], v[72:75], v[40:43], v[168:171]
    v_add_u32 v2, s78, v2
    v_add_u32 v3, s78, v3
    v_add_u32 v31, 16, v31
    s_add_u32 s77, s77, 1
    v_mfma_f32_16x16x32_bf16 v[172:175], v[72:75], v[44:47], v[172:175]
    ds_read_b128 v[96:99], v31
    s_waitcnt lgkmcnt(11)
    v_mfma_f32_16x16x32_bf16 v[176:179], v[76:79], v[32:35], v[176:179]
    ds_read_b64_tr_b16 v[92:93], v7 offset:43008
    v_mfma_f32_16x16x32_bf16 v[180:183], v[76:79], v[36:39], v[180:183]
    ds_read_b64_tr_b16 v[94:95], v7 offset:43264
    v_mfma_f32_16x16x32_bf16 v[184:187], v[76:79], v[40:43], v[184:187]
    v_mfma_f32_16x16x32_bf16 v[188:191], v[76:79], v[44:47], v[188:191]
    s_cmp_gt_u32 s77, 6
    s_waitcnt lgkmcnt(5)
    v_mfma_f32_16x16x32_bf16 v[128:131], v[80:83], v[48:51], v[128:131]
    v_add_u32 v6, s78, v6
    v_add_u32 v7, s78, v7
    v_mfma_f32_16x16x32_bf16 v[132:135], v[80:83], v[52:55], v[132:135]
    s_waitcnt lgkmcnt(2)
    v_or3_b32 v96, v96, v97, v98
    v_mfma_f32_16x16x32_bf16 v[136:139], v[80:83], v[56:59], v[136:139]
    v_or_b32 v96, v96, v99
    v_cmp_eq_u32 vcc, 0, v96
    v_mfma_f32_16x16x32_bf16 v[140:143], v[80:83], v[60:63], v[140:143]
    s_waitcnt lgkmcnt(0)
    s_cbranch_scc1 L_lt_nobar
    s_barrier
L_lt_nobar:
    s_cbranch_vccz L_lt_spin1
L_lt_go1:
    ds_read_b128 v[32:35], v2 offset:0
    ds_read_b64_tr_b16 v[64:65], v6 offset:28672
    v_mfma_f32_16x16x32_bf16 v[144:147], v[84:87], v[48:51], v[144:147]
    ds_read_b64_tr_b16 v[66:67], v6 offset:28928
    v_mfma_f32_16x16x32_bf16 v[148:151], v[84:87], v[52:55], v[148:151]
    ds_read_b128 v[36:39], v2 offset:2048
    v_mfma_f32_16x16x32_bf16 v[152:155], v[84:87], v[56:59], v[152:155]
    ds_read_b128 v[40:43], v2 offset:4096
    v_mfma_f32_16x16x32_bf16 v[156:159], v[84:87], v[60:63], v[156:159]
    ds_read_b128 v[44:47], v2 offset:6144
    v_mfma_f32_16x16x32_bf16 v[160:163], v[88:91], v[48:51], v[160:163]
    ds_read_b64_tr_b16 v[68:69], v7 offset:28672
    v_mfma_f32_16x16x32_bf16 v[164:167], v[88:91], v[52:55], v[164:167]
    ds_read_b64_tr_b16 v[70:71], v7 offset:28928
    v_mfma_f32_16x16x32_bf16 v[168:171], v[88:91], v[56:59], v[168:171]
    ds_read_b64_tr_b16 v[72:73], v6 offset:40960
    v_mfma_f32_16x16x32_bf16 v[172:175], v[88:91], v[60:63], v[172:175]
    ds_read_b64_tr_b16 v[74:75], v6 offset:41216
    v_mfma_f32_16x16x32_bf16 v[176:179], v[92:95], v[48:51], v[176:179]
    ds_read_b64_tr_b16 v[76:77], v7 offset:40960
    v_mfma_f32_16x16x32_bf16 v[180:183], v[92:95], v[52:55], v[180:183]
    ds_read_b64_tr_b16 v[78:79], v7 offset:41216
    v_mfma_f32_16x16x32_bf16 v[184:187], v[92:95], v[56:59], v[184:187]
    s_cmp_lt_u32 s77, 8
    v_mfma_f32_16x16x32_bf16 v[188:191], v[92:95], v[60:63], v[188:191]
    s_cbranch_scc1 L_lt_Ck1
    s_branch L_k1done
L_heavy:
    v_mov_b64 v[48:49], 0
    v_mov_b64 v[50:51], 0
    v_mov_b64 v[52:53], 0
    v_mov_b64 v[54:55], 0
    v_mov_b64 v[56:57], 0
    v_mov_b64 v[58:59], 0
    v_mov_b64 v[60:61], 0
    v_mov_b64 v[62:63], 0
    v_mov_b64 v[80:81], 0
    v_mov_b64 v[82:83], 0
    v_mov_b64 v[84:85], 0
    v_mov_b64 v[86:87], 0
    v_mov_b64 v[88:89], 0
    v_mov_b64 v[90:91], 0
    v_mov_b64 v[92:93], 0
    v_mov_b64 v[94:95], 0
    s_branch L_first1
L_spin1:
    ds_read_b128 v[96:99], v31
    s_waitcnt lgkmcnt(0)
    v_or3_b32 v96, v96, v97, v98
    v_or_b32 v96, v96, v99
    v_cmp_eq_u32 vcc, 0, v96
    s_cbranch_vccz L_spin1
    s_branch L_go1
L_first1:
    ds_read_b128 v[96:99], v31
    s_waitcnt lgkmcnt(0)
    v_and_b32 v96, v96, v97
    v_cmp_eq_u32 vcc, 0, v96
    s_cbranch_vccz L_first1
    global_load_dwordx2 v[100:101], v30, s[62:63] sc1
    s_branch L_spin1
L_Ck1:
    s_waitcnt lgkmcnt(8)
    v_mfma_f32_16x16x32_bf16 v[128:131], v[64:67], v[32:35], v[128:131]
    v_mfma_f32_16x16x32_bf16 v[132:135], v[64:67], v[36:39], v[132:135]
    v_mfma_f32_16x16x32_bf16 v[136:139], v[64:67], v[40:43], v[136:139]
    s_mov_b32 s78, 49152
    v_mfma_f32_16x16x32_bf16 v[140:143], v[64:67], v[44:47], v[140:143]
    ds_read_b64_tr_b16 v[84:85], v7 offset:32768
    ds_read_b64_tr_b16 v[86:87], v7 offset:33024
    s_waitcnt lgkmcnt(8)
    v_mfma_f32_16x16x32_bf16 v[144:147], v[68:71], v[32:35], v[144:147]
    v_mfma_f32_16x16x32_bf16 v[148:151], v[68:71], v[36:39], v[148:151]
    v_mfma_f32_16x16x32_bf16 v[152:155], v[68:71], v[40:43], v[152:155]
    s_movk_i32 s74, 0x24
    v_mfma_f32_16x16x32_bf16 v[156:159], v[68:71], v[44:47], v[156:159]
    ds_read_b64_tr_b16 v[88:89], v6 offset:45056
    ds_read_b64_tr_b16 v[90:91], v6 offset:45312
    s_bitcmp1_b32 s74, s77
    s_cmov_b32 s78, 4294868992
    s_waitcnt lgkmcnt(8)
    v_mfma_f32_16x16x32_bf16 v[160:163], v[72:75], v[32:35], v[160:163]
    v_mfma_f32_16x16x32_bf16 v[164:167], v[72:75], v[36:39], v[164:167]
    v_mfma_f32_16x16x32_bf16 v[168:171], v[72:75], v[40:43], v[168:171]
    ds_read_b128 v[48:51], v3 offset:0
    v_mfma_f32_16x16x32_bf16 v[172:175], v[72:75], v[44:47], v[172:175]
    ds_read_b64_tr_b16 v[92:93], v7 offset:45056
    ds_read_b64_tr_b16 v[94:95], v7 offset:45312
    s_waitcnt lgkmcnt(9)
    v_mfma_f32_16x16x32_bf16 v[176:179], v[76:79], v[32:35], v[176:179]
    v_mfma_f32_16x16x32_bf16 v[180:183], v[76:79], v[36:39], v[180:183]
    v_mfma_f32_16x16x32_bf16 v[184:187], v[76:79], v[40:43], v[184:187]
    ds_read_b128 v[52:55], v3 offset:2048
    v_mfma_f32_16x16x32_bf16 v[188:191], v[76:79], v[44:47], v[188:191]
    ds_read_b64_tr_b16 v[64:65], v6 offset:30720
    ds_read_b64_tr_b16 v[66:67], v6 offset:30976
    v_add_u32 v31, 16, v31
    s_waitcnt lgkmcnt(10)
    v_mfma_f32_16x16x32_bf16 v[192:195], v[80:83], v[32:35], v[192:195]
    v_mfma_f32_16x16x32_bf16 v[196:199], v[80:83], v[36:39], v[196:199]
    v_mfma_f32_16x16x32_bf16 v[200:203], v[80:83], v[40:43], v[200:203]
    ds_read_b128 v[56:59], v3 offset:4096
    v_mfma_f32_16x16x32_bf16 v[204:207], v[80:83], v[44:47], v[204:207]
    ds_read_b64_tr_b16 v[68:69], v7 offset:30720
    ds_read_b64_tr_b16 v[70:71], v7 offset:30976
    s_add_u32 s77, s77, 1
    s_waitcnt lgkmcnt(11)
    v_mfma_f32_16x16x32_bf16 v[208:211], v[84:87], v[32:35], v[208:211]
    v_mfma_f32_16x16x32_bf16 v[212:215], v[84:87], v[36:39], v[212:215]
    v_mfma_f32_16x16x32_bf16 v[216:219], v[84:87], v[40:43], v[216:219]
    ds_read_b128 v[60:63], v3 offset:6144
    v_mfma_f32_16x16x32_bf16 v[220:223], v[84:87], v[44:47], v[220:223]
    ds_read_b64_tr_b16 v[72:73], v6 offset:43008
    ds_read_b64_tr_b16 v[74:75], v6 offset:43264
    s_waitcnt lgkmcnt(12)
    v_mfma_f32_16x16x32_bf16 v[224:227], v[88:91], v[32:35], v[224:227]
    v_mfma_f32_16x16x32_bf16 v[228:231], v[88:91], v[36:39], v[228:231]
    v_mfma_f32_16x16x32_bf16 v[232:235], v[88:91], v[40:43], v[232:235]
    v_add_u32 v2, s78, v2
    v_mfma_f32_16x16x32_bf16 v[236:239], v[88:91], v[44:47], v[236:239]
    ds_read_b64_tr_b16 v[76:77], v7 offset:43008
    ds_read_b64_tr_b16 v[78:79], v7 offset:43264
    s_waitcnt lgkmcnt(11)
    v_mfma_f32_16x16x32_bf16 v[240:243], v[92:95], v[32:35], v[240:243]
    v_mfma_f32_16x16x32_bf16 v[244:247], v[92:95], v[36:39], v[244:247]
    v_mfma_f32_16x16x32_bf16 v[248:251], v[92:95], v[40:43], v[248:251]
    v_add_u32 v3, s78, v3
    v_mfma_f32_16x16x32_bf16 v[252:255], v[92:95], v[44:47], v[252:255]
    ds_read_b64_tr_b16 v[80:81], v6 offset:34816
    ds_read_b64_tr_b16 v[82:83], v6 offset:35072
    s_waitcnt lgkmcnt(6)
    v_mfma_f32_16x16x32_bf16 v[128:131], v[64:67], v[48:51], v[128:131]
    v_mfma_f32_16x16x32_bf16 v[132:135], v[64:67], v[52:55], v[132:135]
    v_mfma_f32_16x16x32_bf16 v[136:139], v[64:67], v[56:59], v[136:139]
    v_mfma_f32_16x16x32_bf16 v[140:143], v[64:67], v[60:63], v[140:143]
    ds_read_b64_tr_b16 v[84:85], v7 offset:34816
    ds_read_b64_tr_b16 v[86:87], v7 offset:35072
    v_mfma_f32_16x16x32_bf16 v[144:147], v[68:71], v[48:51], v[144:147]
    v_mfma_f32_16x16x32_bf16 v[148:151], v[68:71], v[52:55], v[148:151]
    v_mfma_f32_16x16x32_bf16 v[152:155], v[68:71], v[56:59], v[152:155]
    ds_read_b128 v[96:99], v31
    v_mfma_f32_16x16x32_bf16 v[156:159], v[68:71], v[60:63], v[156:159]
    ds_read_b64_tr_b16 v[88:89], v6 offset:47104
    ds_read_b64_tr_b16 v[90:91], v6 offset:47360
    s_waitcnt lgkmcnt(9)
    v_mfma_f32_16x16x32_bf16 v[160:163], v[72:75], v[48:51], v[160:163]
    v_mfma_f32_16x16x32_bf16 v[164:167], v[72:75], v[52:55], v[164:167]
    v_mfma_f32_16x16x32_bf16 v[168:171], v[72:75], v[56:59], v[168:171]
    v_mfma_f32_16x16x32_bf16 v[172:175], v[72:75], v[60:63], v[172:175]
    ds_read_b64_tr_b16 v[92:93], v7 offset:47104
    ds_read_b64_tr_b16 v[94:95], v7 offset:47360
    s_cmp_gt_u32 s77, 6
    s_waitcnt lgkmcnt(9)
    v_mfma_f32_16x16x32_bf16 v[176:179], v[76:79], v[48:51], v[176:179]
    v_add_u32 v6, s78, v6
    v_add_u32 v7, s78, v7
    v_mfma_f32_16x16x32_bf16 v[180:183], v[76:79], v[52:55], v[180:183]
    s_waitcnt lgkmcnt(4)
    v_or3_b32 v96, v96, v97, v98
    v_mfma_f32_16x16x32_bf16 v[184:187], v[76:79], v[56:59], v[184:187]
    v_or_b32 v96, v96, v99
    v_cmp_eq_u32 vcc, 0, v96
    v_mfma_f32_16x16x32_bf16 v[188:191], v[76:79], v[60:63], v[188:191]
    s_waitcnt lgkmcnt(0)
    s_cbranch_scc1 L_nobar
    s_barrier
L_nobar:
    s_cbranch_vccz L_spin1
L_go1:
    ds_read_b128 v[32:35], v2 offset:0
    ds_read_b64_tr_b16 v[64:65], v6 offset:28672
    v_mfma_f32_16x16x32_bf16 v[192:195], v[80:83], v[48:51], v[192:195]
    ds_read_b64_tr_b16 v[66:67], v6 offset:28928
    v_mfma_f32_16x16x32_bf16 v[196:199], v[80:83], v[52:55], v[196:199]
    ds_read_b128 v[36:39], v2 offset:2048
    v_mfma_f32_16x16x32_bf16 v[200:203], v[80:83], v[56:59], v[200:203]
    ds_read_b128 v[40:43], v2 offset:4096
    v_mfma_f32_16x16x32_bf16 v[204:207], v[80:83], v[60:63], v[204:207]
    ds_read_b128 v[44:47], v2 offset:6144
    v_mfma_f32_16x16x32_bf16 v[208:211], v[84:87], v[48:51], v[208:211]
    ds_read_b64_tr_b16 v[68:69], v7 offset:28672
    v_mfma_f32_16x16x32_bf16 v[212:215], v[84:87], v[52:55], v[212:215]
    ds_read_b64_tr_b16 v[70:71], v7 offset:28928
    v_mfma_f32_16x16x32_bf16 v[216:219], v[84:87], v[56:59], v[216:219]
    ds_read_b64_tr_b16 v[72:73], v6 offset:40960
    v_mfma_f32_16x16x32_bf16 v[220:223], v[84:87], v[60:63], v[220:223]
    ds_read_b64_tr_b16 v[74:75], v6 offset:41216
    v_mfma_f32_16x16x32_bf16 v[224:227], v[88:91], v[48:51], v[224:227]
    ds_read_b64_tr_b16 v[76:77], v7 offset:40960
    v_mfma_f32_16x16x32_bf16 v[228:231], v[88:91], v[52:55], v[228:231]
    ds_read_b64_tr_b16 v[78:79], v7 offset:41216
    v_mfma_f32_16x16x32_bf16 v[232:235], v[88:91], v[56:59], v[232:235]
    ds_read_b64_tr_b16 v[80:81], v6 offset:32768
    v_mfma_f32_16x16x32_bf16 v[236:239], v[88:91], v[60:63], v[236:239]
    ds_read_b64_tr_b16 v[82:83], v6 offset:33024
    v_mfma_f32_16x16x32_bf16 v[240:243], v[92:95], v[48:51], v[240:243]
    v_mfma_f32_16x16x32_bf16 v[244:247], v[92:95], v[52:55], v[244:247]
    v_mfma_f32_16x16x32_bf16 v[248:251], v[92:95], v[56:59], v[248:251]
    s_cmp_lt_u32 s77, 8
    v_mfma_f32_16x16x32_bf16 v[252:255], v[92:95], v[60:63], v[252:255]
    s_cbranch_scc1 L_Ck1
L_k1done:
    s_lshl_b32 s74, s65, 7
    s_lshl_b32 s75, s68, 6
    s_add_u32 s74, s74, s75
    s_lshl_b32 s75, s66, 2
    s_add_u32 s74, s74, s75
    s_lshl_b32 s48, s74, 10
    s_mov_b64 s[50:51], s[60:61]
    v_mov_b32 v5, 1
    ds_write_b32 v29, v5
    s_setprio 3
    v_mov_b32 v31, v29
    s_waitcnt vmcnt(0)
    v_mov_b64 v[92:93], v[100:101]
    s_mov_b32 s79, 0
L_tag1:
    v_readfirstlane_b32 s61, v93
    s_nop 0
    s_cmp_lg_u32 s61, 0
    s_cbranch_scc1 L_tag1ok
    global_load_dwordx2 v[92:93], v30, s[62:63] sc1
    s_waitcnt vmcnt(0)
    s_add_u32 s79, s79, 1
    s_cmp_lt_u32 s79, 2097152
    s_cbranch_scc1 L_tag1
L_tag1ok:
    v_readfirstlane_b32 s60, v92
    v_lshlrev_b32 v30, 4, v1
    global_load_dwordx4 v[112:115], v30, s[50:51]
    buffer_load_dwordx4 v[96:99], v30, s[4:7], s48 offen offset:0
    buffer_load_dwordx4 v[100:103], v30, s[4:7], s48 offen offset:1024
    buffer_load_dwordx4 v[104:107], v30, s[4:7], s48 offen offset:2048
    buffer_load_dwordx4 v[108:111], v30, s[4:7], s48 offen offset:3072
    s_lshl_b32 s74, s65, 1
    s_add_u32 s77, s74, s68
    s_mul_i32 s74, s77, 307200
    v_lshl_add_u32 v2, v1, 4, s74
    v_and_b32 v3, 15, v1
    v_lshl_add_u32 v3, v3, 4, s74
    v_bfe_u32 v6, v1, 4, 1
    v_lshl_add_u32 v3, v6, 9, v3
    v_lshrrev_b32 v6, 5, v1
    v_lshl_add_u32 v3, v6, 11, v3
    s_lshl_b32 s77, s77, 13
    s_lshl_b32 s74, s66, 9
    s_add_u32 s77, s77, s74
    s_add_u32 s77, s77, 10747904
    s_add_u32 s74, s67, 33
    s_lshl_b32 s74, s74, 12
    v_pk_mul_f32 v[128:129], v[128:129], v[160:161]
    v_pk_mul_f32 v[130:131], v[130:131], v[162:163]
    v_pk_mul_f32 v[144:145], v[144:145], v[176:177]
    v_pk_mul_f32 v[146:147], v[146:147], v[178:179]
    v_cvt_pk_bf16_f32 v48, v128, v129
    v_cvt_pk_bf16_f32 v49, v130, v131
    v_cvt_pk_bf16_f32 v50, v144, v145
    v_cvt_pk_bf16_f32 v51, v146, v147
    buffer_store_dwordx4 v[48:51], v3, s[24:27], s74 offen offset:0 sc1
    v_pk_mul_f32 v[132:133], v[132:133], v[164:165]
    v_pk_mul_f32 v[134:135], v[134:135], v[166:167]
    v_pk_mul_f32 v[148:149], v[148:149], v[180:181]
    v_pk_mul_f32 v[150:151], v[150:151], v[182:183]
    v_cvt_pk_bf16_f32 v52, v132, v133
    v_cvt_pk_bf16_f32 v53, v134, v135
    v_cvt_pk_bf16_f32 v54, v148, v149
    v_cvt_pk_bf16_f32 v55, v150, v151
    buffer_store_dwordx4 v[52:55], v3, s[24:27], s74 offen offset:256 sc1
    v_pk_mul_f32 v[136:137], v[136:137], v[168:169]
    v_pk_mul_f32 v[138:139], v[138:139], v[170:171]
    v_pk_mul_f32 v[152:153], v[152:153], v[184:185]
    v_pk_mul_f32 v[154:155], v[154:155], v[186:187]
    v_cvt_pk_bf16_f32 v56, v136, v137
    v_cvt_pk_bf16_f32 v57, v138, v139
    v_cvt_pk_bf16_f32 v58, v152, v153
    v_cvt_pk_bf16_f32 v59, v154, v155
    buffer_store_dwordx4 v[56:59], v3, s[24:27], s74 offen offset:1024 sc1
    v_pk_mul_f32 v[140:141], v[140:141], v[172:173]
    v_pk_mul_f32 v[142:143], v[142:143], v[174:175]
    v_pk_mul_f32 v[156:157], v[156:157], v[188:189]
    v_pk_mul_f32 v[158:159], v[158:159], v[190:191]
    v_cvt_pk_bf16_f32 v60, v140, v141
    v_cvt_pk_bf16_f32 v61, v142, v143
    v_cvt_pk_bf16_f32 v62, v156, v157
    v_cvt_pk_bf16_f32 v63, v158, v159
    buffer_store_dwordx4 v[60:63], v3, s[24:27], s74 offen offset:1280 sc1
    s_cmp_eq_u32 s73, 2
    s_cbranch_scc1 L_light
    s_add_u32 s74, s74, 4096
    v_pk_mul_f32 v[192:193], v[192:193], v[224:225]
    v_pk_mul_f32 v[194:195], v[194:195], v[226:227]
    v_pk_mul_f32 v[208:209], v[208:209], v[240:241]
    v_pk_mul_f32 v[210:211], v[210:211], v[242:243]
    v_cvt_pk_bf16_f32 v160, v192, v193
    v_cvt_pk_bf16_f32 v161, v194, v195
    v_cvt_pk_bf16_f32 v162, v208, v209
    v_cvt_pk_bf16_f32 v163, v210, v211
    buffer_store_dwordx4 v[160:163], v3, s[24:27], s74 offen offset:0 sc1
    v_pk_mul_f32 v[196:197], v[196:197], v[228:229]
    v_pk_mul_f32 v[198:199], v[198:199], v[230:231]
    v_pk_mul_f32 v[212:213], v[212:213], v[244:245]
    v_pk_mul_f32 v[214:215], v[214:215], v[246:247]
    v_cvt_pk_bf16_f32 v164, v196, v197
    v_cvt_pk_bf16_f32 v165, v198, v199
    v_cvt_pk_bf16_f32 v166, v212, v213
    v_cvt_pk_bf16_f32 v167, v214, v215
    buffer_store_dwordx4 v[164:167], v3, s[24:27], s74 offen offset:256 sc1
    v_pk_mul_f32 v[200:201], v[200:201], v[232:233]
    v_pk_mul_f32 v[202:203], v[202:203], v[234:235]
    v_pk_mul_f32 v[216:217], v[216:217], v[248:249]
    v_pk_mul_f32 v[218:219], v[218:219], v[250:251]
    v_cvt_pk_bf16_f32 v168, v200, v201
    v_cvt_pk_bf16_f32 v169, v202, v203
    v_cvt_pk_bf16_f32 v170, v216, v217
    v_cvt_pk_bf16_f32 v171, v218, v219
    buffer_store_dwordx4 v[168:171], v3, s[24:27], s74 offen offset:1024 sc1
    v_pk_mul_f32 v[204:205], v[204:205], v[236:237]
    v_pk_mul_f32 v[206:207], v[206:207], v[238:239]
    v_pk_mul_f32 v[220:221], v[220:221], v[252:253]
    v_pk_mul_f32 v[222:223], v[222:223], v[254:255]
    v_cvt_pk_bf16_f32 v172, v204, v205
    v_cvt_pk_bf16_f32 v173, v206, v207
    v_cvt_pk_bf16_f32 v174, v220, v221
    v_cvt_pk_bf16_f32 v175, v222, v223
    buffer_store_dwordx4 v[172:175], v3, s[24:27], s74 offen offset:1280 sc1
    s_waitcnt vmcnt(8) lgkmcnt(0)
    s_branch L_light2
L_light:
    s_waitcnt vmcnt(4) lgkmcnt(0)
L_light2:
    v_lshlrev_b32 v72, 16, v112
    v_and_b32 v73, 0xffff0000, v112
    v_lshlrev_b32 v74, 16, v113
    v_and_b32 v75, 0xffff0000, v113
    v_lshlrev_b32 v76, 16, v114
    v_and_b32 v77, 0xffff0000, v114
    v_lshlrev_b32 v78, 16, v115
    v_and_b32 v79, 0xffff0000, v115
    v_mov_b64 v[80:81], 0
    v_mov_b64 v[82:83], 0
    s_mov_b32 s74, 0x3f803f80
    v_lshlrev_b32 v84, 16, v96
    v_and_b32 v85, 0xffff0000, v96
    v_pk_mul_f32 v[84:85], v[84:85], v[72:73]
    v_cvt_pk_bf16_f32 v84, v84, v85
    v_dot2c_f32_bf16 v80, s74, v84
    v_lshlrev_b32 v86, 16, v100
    v_and_b32 v87, 0xffff0000, v100
    v_pk_mul_f32 v[86:87], v[86:87], v[72:73]
    v_cvt_pk_bf16_f32 v86, v86, v87
    v_dot2c_f32_bf16 v81, s74, v86
    v_lshlrev_b32 v88, 16, v104
    v_and_b32 v89, 0xffff0000, v104
    v_pk_mul_f32 v[88:89], v[88:89], v[72:73]
    v_cvt_pk_bf16_f32 v88, v88, v89
    v_dot2c_f32_bf16 v82, s74, v88
    v_lshlrev_b32 v90, 16, v108
    v_and_b32 v91, 0xffff0000, v108
    v_pk_mul_f32 v[90:91], v[90:91], v[72:73]
    v_cvt_pk_bf16_f32 v90, v90, v91
    v_dot2c_f32_bf16 v83, s74, v90
    v_lshlrev_b32 v84, 16, v97
    v_and_b32 v85, 0xffff0000, v97
    v_pk_mul_f32 v[84:85], v[84:85], v[74:75]
    v_cvt_pk_bf16_f32 v84, v84, v85
    v_dot2c_f32_bf16 v80, s74, v84
    v_lshlrev_b32 v86, 16, v101
    v_and_b32 v87, 0xffff0000, v101
    v_pk_mul_f32 v[86:87], v[86:87], v[74:75]
    v_cvt_pk_bf16_f32 v86, v86, v87
    v_dot2c_f32_bf16 v81, s74, v86
    v_lshlrev_b32 v88, 16, v105
    v_and_b32 v89, 0xffff0000, v105
    v_pk_mul_f32 v[88:89], v[88:89], v[74:75]
    v_cvt_pk_bf16_f32 v88, v88, v89
    v_dot2c_f32_bf16 v82, s74, v88
    v_lshlrev_b32 v90, 16, v109
    v_and_b32 v91, 0xffff0000, v109
    v_pk_mul_f32 v[90:91], v[90:91], v[74:75]
    v_cvt_pk_bf16_f32 v90, v90, v91
    v_dot2c_f32_bf16 v83, s74, v90
    v_lshlrev_b32 v84, 16, v98
    v_and_b32 v85, 0xffff0000, v98
    v_pk_mul_f32 v[84:85], v[84:85], v[76:77]
    v_cvt_pk_bf16_f32 v84, v84, v85
    v_dot2c_f32_bf16 v80, s74, v84
    v_lshlrev_b32 v86, 16, v102
    v_and_b32 v87, 0xffff0000, v102
    v_pk_mul_f32 v[86:87], v[86:87], v[76:77]
    v_cvt_pk_bf16_f32 v86, v86, v87
    v_dot2c_f32_bf16 v81, s74, v86
    v_lshlrev_b32 v88, 16, v106
    v_and_b32 v89, 0xffff0000, v106
    v_pk_mul_f32 v[88:89], v[88:89], v[76:77]
    v_cvt_pk_bf16_f32 v88, v88, v89
    v_dot2c_f32_bf16 v82, s74, v88
    v_lshlrev_b32 v90, 16, v110
    v_and_b32 v91, 0xffff0000, v110
    v_pk_mul_f32 v[90:91], v[90:91], v[76:77]
    v_cvt_pk_bf16_f32 v90, v90, v91
    v_dot2c_f32_bf16 v83, s74, v90
    v_lshlrev_b32 v84, 16, v99
    v_and_b32 v85, 0xffff0000, v99
    v_pk_mul_f32 v[84:85], v[84:85], v[78:79]
    v_cvt_pk_bf16_f32 v84, v84, v85
    v_dot2c_f32_bf16 v80, s74, v84
    v_lshlrev_b32 v86, 16, v103
    v_and_b32 v87, 0xffff0000, v103
    v_pk_mul_f32 v[86:87], v[86:87], v[78:79]
    v_cvt_pk_bf16_f32 v86, v86, v87
    v_dot2c_f32_bf16 v81, s74, v86
    v_lshlrev_b32 v88, 16, v107
    v_and_b32 v89, 0xffff0000, v107
    v_pk_mul_f32 v[88:89], v[88:89], v[78:79]
    v_cvt_pk_bf16_f32 v88, v88, v89
    v_dot2c_f32_bf16 v82, s74, v88
    v_lshlrev_b32 v90, 16, v111
    v_and_b32 v91, 0xffff0000, v111
    v_pk_mul_f32 v[90:91], v[90:91], v[78:79]
    v_cvt_pk_bf16_f32 v90, v90, v91
    v_dot2c_f32_bf16 v83, s74, v90
    v_permlane32_swap_b32 v80, v81
    s_nop 1
    v_permlane32_swap_b32 v82, v83
    v_add_f32 v80, v80, v81
    v_add_f32 v82, v82, v83
    s_nop 1
    v_permlane16_swap_b32 v80, v82
    v_add_f32 v80, v80, v82
    s_nop 1
    v_add_f32_dpp v80, v80, v80 quad_perm:[1,0,3,2] row_mask:0xf bank_mask:0xf
    s_nop 1
    v_add_f32_dpp v80, v80, v80 quad_perm:[2,3,0,1] row_mask:0xf bank_mask:0xf
    s_nop 1
    v_add_f32_dpp v80, v80, v80 row_half_mirror row_mask:0xf bank_mask:0xf
    s_nop 1
    v_add_f32_dpp v80, v80, v80 row_mirror row_mask:0xf bank_mask:0xf
    v_cvt_pk_bf16_f32 v80, v80, v80
    v_and_b32 v80, 0xffff0000, v80
    v_mul_f32 v80, 0xbfb8aa3b, v80
    v_exp_f32 v80, v80
    s_nop 0
    v_add_f32 v80, 1.0, v80
    v_rcp_f32 v80, v80
    s_nop 0
    v_cvt_pk_bf16_f32 v80, v80, v80
    v_and_b32 v80, 0xffff0000, v80
    s_nop 0
    v_readlane_b32 s48, v80, 0
    v_readlane_b32 s49, v80, 32
    v_readlane_b32 s50, v80, 16
    v_readlane_b32 s51, v80, 48
    v_mov_b32 v94, s48
    v_mov_b32 v95, s49
    v_writelane_b32 v94, s50, 1
    v_writelane_b32 v95, s51, 1
    s_waitcnt vmcnt(0)
    s_mov_b64 exec, 0xff
    buffer_store_dwordx4 v[92:95], v30, s[24:27], s77 offen offset:128 sc1
    s_mov_b64 exec, -1
    s_branch L_P2
L_C0:
    v_and_b32 v27, 31, v1
    v_lshlrev_b32 v27, 1, v27
    v_add_u32 v27, 150528, v27
    ds_read_u16 v84, v27 offset:0
    ds_read_u16 v85, v27 offset:64
    ds_read_u16 v86, v27 offset:128
    s_waitcnt lgkmcnt(0)
    v_lshlrev_b32 v84, 16, v84
    v_lshlrev_b32 v85, 16, v85
    v_lshlrev_b32 v86, 16, v86
    v_mul_f32 v86, 0x3fb8aa3b, v86
    v_exp_f32 v86, v86
    s_nop 0
    v_cvt_pk_bf16_f32 v86, v86, v86
    v_and_b32 v86, 0xffff0000, v86
    v_mul_f32 v88, v86, v84
    v_mul_f32 v89, v86, v85
    v_mul_f32 v88, 0x3fb8aa3b, v88
    v_exp_f32 v88, v88
    v_mul_f32 v89, 0.15915494, v89
    v_rndne_f32 v90, v89
    v_sub_f32 v89, v89, v90
    v_cos_f32 v90, v89
    v_sin_f32 v91, v89
    v_mul_f32 v8, v88, v90
    v_mul_f32 v9, v88, v91
    v_add_f32 v88, -1.0, v8
    v_mul_f32 v89, v84, v84
    v_fmac_f32 v89, v85, v85
    v_rcp_f32 v89, v89
    v_mul_f32 v16, v88, v84
    v_fmac_f32 v16, v9, v85
    v_mul_f32 v17, v9, v84
    v_fma_f32 v17, -v88, v85, v17
    v_mul_f32 v16, v16, v89
    v_mul_f32 v17, v17, v89
    v_mul_f32 v12, v8, v8
    v_mul_f32 v13, v8, v9
    v_fma_f32 v12, -v9, v9, v12
    v_add_f32 v13, v13, v13
    v_mul_f32 v90, v12, v12
    v_mul_f32 v91, v12, v13
    v_fma_f32 v90, -v13, v13, v90
    v_add_f32 v91, v91, v91
    v_mul_f32 v88, v90, v90
    v_mul_f32 v89, v90, v91
    v_fma_f32 v88, -v91, v91, v88
    v_add_f32 v89, v89, v89
    v_mul_f32 v22, v88, v88
    v_mul_f32 v23, v88, v89
    v_fma_f32 v22, -v89, v89, v22
    v_add_f32 v23, v23, v23
    v_mul_f32 v88, v22, v22
    v_mul_f32 v89, v22, v23
    v_fma_f32 v88, -v23, v23, v88
    v_add_f32 v89, v89, v89
    v_mul_f32 v90, v88, v88
    v_mul_f32 v91, v88, v89
    v_fma_f32 v90, -v89, v89, v90
    v_add_f32 v91, v91, v91
    v_mul_f32 v24, v90, v90
    v_mul_f32 v25, v90, v91
    v_fma_f32 v24, -v91, v91, v24
    v_add_f32 v25, v25, v25
    v_mul_f32 v26, v24, v24
    v_mul_f32 v27, v24, v25
    v_fma_f32 v26, -v25, v25, v26
    v_add_f32 v27, v27, v27
    v_cmp_lt_u32 vcc, 31, v1
    s_nop 1
    v_cndmask_b32 v120, 1.0, v88, vcc
    v_cndmask_b32 v122, 0, v89, vcc
    s_cmp_eq_u32 s68, 0
    s_cbranch_scc1 L_nb
    v_mul_f32 v92, v90, v120
    v_mul_f32 v93, v90, v122
    v_fma_f32 v92, -v91, v122, v92
    v_fma_f32 v93, v91, v120, v93
    v_mov_b32 v120, v92
    v_mov_b32 v122, v93
L_nb:
    v_mul_f32 v121, v22, v120
    v_mul_f32 v123, v22, v122
    v_fma_f32 v121, -v23, v122, v121
    v_fma_f32 v123, v23, v120, v123
    v_mov_b64 v[10:11], v[8:9]
    v_mov_b64 v[14:15], v[12:13]
    v_mov_b64 v[18:19], v[16:17]
    v_permlane16_swap_b32 v8, v10
    v_permlane16_swap_b32 v9, v11
    v_permlane16_swap_b32 v12, v14
    v_permlane16_swap_b32 v13, v15
    v_permlane16_swap_b32 v16, v18
    v_permlane16_swap_b32 v17, v19
    v_sub_f32 v20, 0, v9
    v_mov_b32 v124, v13
    v_sub_f32 v21, 0, v11
    v_mov_b32 v126, v15
    v_mov_b64 v[48:49], 0
    v_mov_b64 v[50:51], 0
    v_mov_b64 v[52:53], 0
    v_mov_b64 v[54:55], 0
    v_mov_b64 v[56:57], 0
    v_mov_b64 v[58:59], 0
    v_mov_b64 v[60:61], 0
    v_mov_b64 v[62:63], 0
    v_mov_b64 v[80:81], 0
    v_mov_b64 v[82:83], 0
    v_mov_b64 v[84:85], 0
    v_mov_b64 v[86:87], 0
    v_mov_b64 v[88:89], 0
    v_mov_b64 v[90:91], 0
    v_mov_b64 v[92:93], 0
    v_mov_b64 v[94:95], 0
    s_branch L_first0
L_spin0:
    ds_read_b128 v[96:99], v31
    s_waitcnt lgkmcnt(0)
    v_or3_b32 v96, v96, v97, v98
    v_or_b32 v96, v96, v99
    v_cmp_eq_u32 vcc, 0, v96
    s_cbranch_vccz L_spin0
    s_branch L_go0
L_first0:
    ds_read_b128 v[96:99], v31
    s_waitcnt lgkmcnt(0)
    v_and_b32 v96, v96, v97
    v_cmp_eq_u32 vcc, 0, v96
    s_cbranch_vccz L_first0
    global_load_dwordx2 v[100:101], v30, s[62:63] sc1
    s_branch L_spin0
L_Ck0:
    s_waitcnt lgkmcnt(5)
    v_mfma_f32_16x16x32_bf16 v[128:131], v[32:35], v[64:67], v[128:131]
    v_mfma_f32_16x16x32_bf16 v[132:135], v[36:39], v[64:67], v[132:135]
    v_mfma_f32_16x16x32_bf16 v[136:139], v[40:43], v[64:67], v[136:139]
    s_mov_b32 s78, 49152
    v_mfma_f32_16x16x32_bf16 v[140:143], v[44:47], v[64:67], v[140:143]
    ds_read_b64_tr_b16 v[84:85], v7 offset:24576
    ds_read_b64_tr_b16 v[86:87], v7 offset:24832
    s_waitcnt lgkmcnt(6)
    v_mfma_f32_16x16x32_bf16 v[144:147], v[32:35], v[68:71], v[144:147]
    v_mfma_f32_16x16x32_bf16 v[148:151], v[36:39], v[68:71], v[148:151]
    v_mfma_f32_16x16x32_bf16 v[152:155], v[40:43], v[68:71], v[152:155]
    s_movk_i32 s74, 0x24
    v_mfma_f32_16x16x32_bf16 v[156:159], v[44:47], v[68:71], v[156:159]
    ds_read_b64_tr_b16 v[88:89], v6 offset:36864
    ds_read_b64_tr_b16 v[90:91], v6 offset:37120
    s_bitcmp1_b32 s74, s77
    s_cmov_b32 s78, 4294868992
    s_waitcnt lgkmcnt(7)
    v_mfma_f32_16x16x32_bf16 v[160:163], v[32:35], v[72:75], v[160:163]
    v_mfma_f32_16x16x32_bf16 v[164:167], v[36:39], v[72:75], v[164:167]
    v_mfma_f32_16x16x32_bf16 v[168:171], v[40:43], v[72:75], v[168:171]
    ds_read_b128 v[48:51], v3 offset:0
    v_mfma_f32_16x16x32_bf16 v[172:175], v[44:47], v[72:75], v[172:175]
    ds_read_b64_tr_b16 v[92:93], v7 offset:36864
    ds_read_b64_tr_b16 v[94:95], v7 offset:37120
    s_waitcnt lgkmcnt(9)
    v_mfma_f32_16x16x32_bf16 v[176:179], v[32:35], v[76:79], v[176:179]
    v_mfma_f32_16x16x32_bf16 v[180:183], v[36:39], v[76:79], v[180:183]
    v_mfma_f32_16x16x32_bf16 v[184:187], v[40:43], v[76:79], v[184:187]
    ds_read_b128 v[52:55], v3 offset:2048
    v_mfma_f32_16x16x32_bf16 v[188:191], v[44:47], v[76:79], v[188:191]
    ds_read_b128 v[64:67], v5 offset:16384
    v_add_u32 v31, 16, v31
    s_waitcnt lgkmcnt(9)
    v_mfma_f32_16x16x32_bf16 v[192:195], v[80:83], v[32:35], v[192:195]
    v_mfma_f32_16x16x32_bf16 v[196:199], v[80:83], v[36:39], v[196:199]
    v_mfma_f32_16x16x32_bf16 v[200:203], v[80:83], v[40:43], v[200:203]
    ds_read_b128 v[56:59], v3 offset:4096
    v_mfma_f32_16x16x32_bf16 v[204:207], v[80:83], v[44:47], v[204:207]
    ds_read_b128 v[68:71], v5 offset:18432
    s_add_u32 s77, s77, 1
    s_waitcnt lgkmcnt(9)
    v_mfma_f32_16x16x32_bf16 v[208:211], v[84:87], v[32:35], v[208:211]
    v_mfma_f32_16x16x32_bf16 v[212:215], v[84:87], v[36:39], v[212:215]
    v_mfma_f32_16x16x32_bf16 v[216:219], v[84:87], v[40:43], v[216:219]
    ds_read_b128 v[60:63], v3 offset:6144
    v_mfma_f32_16x16x32_bf16 v[220:223], v[84:87], v[44:47], v[220:223]
    ds_read_b128 v[72:75], v5 offset:20480
    s_waitcnt lgkmcnt(9)
    v_mfma_f32_16x16x32_bf16 v[224:227], v[88:91], v[32:35], v[224:227]
    v_mfma_f32_16x16x32_bf16 v[228:231], v[88:91], v[36:39], v[228:231]
    v_mfma_f32_16x16x32_bf16 v[232:235], v[88:91], v[40:43], v[232:235]
    v_add_u32 v2, s78, v2
    v_mfma_f32_16x16x32_bf16 v[236:239], v[88:91], v[44:47], v[236:239]
    ds_read_b128 v[76:79], v5 offset:22528
    s_waitcnt lgkmcnt(7)
    v_mfma_f32_16x16x32_bf16 v[240:243], v[92:95], v[32:35], v[240:243]
    v_mfma_f32_16x16x32_bf16 v[244:247], v[92:95], v[36:39], v[244:247]
    v_mfma_f32_16x16x32_bf16 v[248:251], v[92:95], v[40:43], v[248:251]
    v_add_u32 v3, s78, v3
    v_mfma_f32_16x16x32_bf16 v[252:255], v[92:95], v[44:47], v[252:255]
    ds_read_b64_tr_b16 v[80:81], v6 offset:26624
    ds_read_b64_tr_b16 v[82:83], v6 offset:26880
    s_waitcnt lgkmcnt(4)
    v_mfma_f32_16x16x32_bf16 v[128:131], v[48:51], v[64:67], v[128:131]
    v_mfma_f32_16x16x32_bf16 v[132:135], v[52:55], v[64:67], v[132:135]
    v_mfma_f32_16x16x32_bf16 v[136:139], v[56:59], v[64:67], v[136:139]
    v_add_u32 v4, s78, v4
    v_mfma_f32_16x16x32_bf16 v[140:143], v[60:63], v[64:67], v[140:143]
    ds_read_b64_tr_b16 v[84:85], v7 offset:26624
    ds_read_b64_tr_b16 v[86:87], v7 offset:26880
    v_mfma_f32_16x16x32_bf16 v[144:147], v[48:51], v[68:71], v[144:147]
    v_mfma_f32_16x16x32_bf16 v[148:151], v[52:55], v[68:71], v[148:151]
    v_mfma_f32_16x16x32_bf16 v[152:155], v[56:59], v[68:71], v[152:155]
    ds_read_b128 v[96:99], v31
    v_mfma_f32_16x16x32_bf16 v[156:159], v[60:63], v[68:71], v[156:159]
    ds_read_b64_tr_b16 v[88:89], v6 offset:38912
    ds_read_b64_tr_b16 v[90:91], v6 offset:39168
    s_waitcnt lgkmcnt(8)
    v_mfma_f32_16x16x32_bf16 v[160:163], v[48:51], v[72:75], v[160:163]
    v_mfma_f32_16x16x32_bf16 v[164:167], v[52:55], v[72:75], v[164:167]
    v_mfma_f32_16x16x32_bf16 v[168:171], v[56:59], v[72:75], v[168:171]
    v_add_u32 v5, s78, v5
    v_mfma_f32_16x16x32_bf16 v[172:175], v[60:63], v[72:75], v[172:175]
    ds_read_b64_tr_b16 v[92:93], v7 offset:38912
    ds_read_b64_tr_b16 v[94:95], v7 offset:39168
    s_waitcnt lgkmcnt(9)
    v_mfma_f32_16x16x32_bf16 v[176:179], v[48:51], v[76:79], v[176:179]
    v_add_u32 v6, s78, v6
    v_add_u32 v7, s78, v7
    v_mfma_f32_16x16x32_bf16 v[180:183], v[52:55], v[76:79], v[180:183]
    s_waitcnt lgkmcnt(4)
    v_or3_b32 v96, v96, v97, v98
    v_mfma_f32_16x16x32_bf16 v[184:187], v[56:59], v[76:79], v[184:187]
    v_or_b32 v96, v96, v99
    v_cmp_eq_u32 vcc, 0, v96
    v_mfma_f32_16x16x32_bf16 v[188:191], v[60:63], v[76:79], v[188:191]
    s_waitcnt lgkmcnt(0)
    s_barrier
    s_cbranch_vccz L_spin0
L_go0:
    ds_read_b128 v[32:35], v2 offset:0
    ds_read_b128 v[64:67], v4 offset:16384
    v_mfma_f32_16x16x32_bf16 v[192:195], v[80:83], v[48:51], v[192:195]
    v_mfma_f32_16x16x32_bf16 v[196:199], v[80:83], v[52:55], v[196:199]
    ds_read_b128 v[36:39], v2 offset:2048
    v_mfma_f32_16x16x32_bf16 v[200:203], v[80:83], v[56:59], v[200:203]
    ds_read_b128 v[40:43], v2 offset:4096
    v_mfma_f32_16x16x32_bf16 v[204:207], v[80:83], v[60:63], v[204:207]
    ds_read_b128 v[44:47], v2 offset:6144
    v_mfma_f32_16x16x32_bf16 v[208:211], v[84:87], v[48:51], v[208:211]
    ds_read_b128 v[68:71], v4 offset:18432
    v_mfma_f32_16x16x32_bf16 v[212:215], v[84:87], v[52:55], v[212:215]
    v_mfma_f32_16x16x32_bf16 v[216:219], v[84:87], v[56:59], v[216:219]
    ds_read_b128 v[72:75], v4 offset:20480
    v_mfma_f32_16x16x32_bf16 v[220:223], v[84:87], v[60:63], v[220:223]
    v_mfma_f32_16x16x32_bf16 v[224:227], v[88:91], v[48:51], v[224:227]
    ds_read_b128 v[76:79], v4 offset:22528
    v_mfma_f32_16x16x32_bf16 v[228:231], v[88:91], v[52:55], v[228:231]
    v_mfma_f32_16x16x32_bf16 v[232:235], v[88:91], v[56:59], v[232:235]
    ds_read_b64_tr_b16 v[80:81], v6 offset:24576
    v_mfma_f32_16x16x32_bf16 v[236:239], v[88:91], v[60:63], v[236:239]
    ds_read_b64_tr_b16 v[82:83], v6 offset:24832
    v_mfma_f32_16x16x32_bf16 v[240:243], v[92:95], v[48:51], v[240:243]
    v_mfma_f32_16x16x32_bf16 v[244:247], v[92:95], v[52:55], v[244:247]
    v_mfma_f32_16x16x32_bf16 v[248:251], v[92:95], v[56:59], v[248:251]
    s_cmp_lt_u32 s77, 6
    v_mfma_f32_16x16x32_bf16 v[252:255], v[92:95], v[60:63], v[252:255]
    s_cbranch_scc1 L_Ck0
    ds_read_b128 v[96:99], v31 offset:16
    s_waitcnt lgkmcnt(9)
    v_mfma_f32_16x16x32_bf16 v[128:131], v[32:35], v[64:67], v[128:131]
    ds_read_b128 v[48:51], v3 offset:0
    s_waitcnt lgkmcnt(9)
    v_mfma_f32_16x16x32_bf16 v[132:135], v[36:39], v[64:67], v[132:135]
    ds_read_b128 v[52:55], v3 offset:2048
    s_waitcnt lgkmcnt(9)
    v_mfma_f32_16x16x32_bf16 v[136:139], v[40:43], v[64:67], v[136:139]
    s_waitcnt lgkmcnt(8)
    v_mfma_f32_16x16x32_bf16 v[140:143], v[44:47], v[64:67], v[140:143]
    ds_read_b128 v[64:67], v5 offset:16384
    s_waitcnt lgkmcnt(8)
    v_mfma_f32_16x16x32_bf16 v[144:147], v[32:35], v[68:71], v[144:147]
    ds_read_b128 v[56:59], v3 offset:4096
    v_mfma_f32_16x16x32_bf16 v[148:151], v[36:39], v[68:71], v[148:151]
    ds_read_b128 v[60:63], v3 offset:6144
    v_mfma_f32_16x16x32_bf16 v[152:155], v[40:43], v[68:71], v[152:155]
    v_mfma_f32_16x16x32_bf16 v[156:159], v[44:47], v[68:71], v[156:159]
    ds_read_b128 v[68:71], v5 offset:18432
    s_waitcnt lgkmcnt(10)
    v_mfma_f32_16x16x32_bf16 v[160:163], v[32:35], v[72:75], v[160:163]
    v_mfma_f32_16x16x32_bf16 v[164:167], v[36:39], v[72:75], v[164:167]
    v_mfma_f32_16x16x32_bf16 v[168:171], v[40:43], v[72:75], v[168:171]
    v_mfma_f32_16x16x32_bf16 v[172:175], v[44:47], v[72:75], v[172:175]
    ds_read_b128 v[72:75], v5 offset:20480
    s_waitcnt lgkmcnt(10)
    v_mfma_f32_16x16x32_bf16 v[176:179], v[32:35], v[76:79], v[176:179]
    v_mfma_f32_16x16x32_bf16 v[180:183], v[36:39], v[76:79], v[180:183]
    v_mfma_f32_16x16x32_bf16 v[184:187], v[40:43], v[76:79], v[184:187]
    v_mfma_f32_16x16x32_bf16 v[188:191], v[44:47], v[76:79], v[188:191]
    ds_read_b128 v[76:79], v5 offset:22528
    s_waitcnt lgkmcnt(8)
L_t7:
    v_or3_b32 v96, v96, v97, v98
    v_or_b32 v96, v96, v99
    v_cmp_eq_u32 vcc, 0, v96
    s_cbranch_vccnz L_t7ok
    ds_read_b128 v[96:99], v31 offset:16
    s_waitcnt lgkmcnt(0)
    s_branch L_t7
L_t7ok:
    v_add_u32 v4, 49152, v4
    v_add_u32 v5, 49152, v5
    s_waitcnt lgkmcnt(5)
    v_mfma_f32_16x16x32_bf16 v[128:131], v[48:51], v[64:67], v[128:131]
    ds_read_b128 v[32:35], v2 offset:49152
    v_mfma_f32_16x16x32_bf16 v[132:135], v[52:55], v[64:67], v[132:135]
    ds_read_b128 v[36:39], v2 offset:51200
    s_waitcnt lgkmcnt(6)
    v_mfma_f32_16x16x32_bf16 v[136:139], v[56:59], v[64:67], v[136:139]
    s_waitcnt lgkmcnt(5)
    v_mfma_f32_16x16x32_bf16 v[140:143], v[60:63], v[64:67], v[140:143]
    ds_read_b128 v[64:67], v4 offset:16384
    s_waitcnt lgkmcnt(5)
    v_mfma_f32_16x16x32_bf16 v[144:147], v[48:51], v[68:71], v[144:147]
    ds_read_b128 v[40:43], v2 offset:53248
    v_mfma_f32_16x16x32_bf16 v[148:151], v[52:55], v[68:71], v[148:151]
    ds_read_b128 v[44:47], v2 offset:55296
    v_mfma_f32_16x16x32_bf16 v[152:155], v[56:59], v[68:71], v[152:155]
    v_mfma_f32_16x16x32_bf16 v[156:159], v[60:63], v[68:71], v[156:159]
    ds_read_b128 v[68:71], v4 offset:18432
    s_waitcnt lgkmcnt(7)
    v_mfma_f32_16x16x32_bf16 v[160:163], v[48:51], v[72:75], v[160:163]
    v_mfma_f32_16x16x32_bf16 v[164:167], v[52:55], v[72:75], v[164:167]
    v_mfma_f32_16x16x32_bf16 v[168:171], v[56:59], v[72:75], v[168:171]
    v_mfma_f32_16x16x32_bf16 v[172:175], v[60:63], v[72:75], v[172:175]
    ds_read_b128 v[72:75], v4 offset:20480
    s_waitcnt lgkmcnt(7)
    v_mfma_f32_16x16x32_bf16 v[176:179], v[48:51], v[76:79], v[176:179]
    v_mfma_f32_16x16x32_bf16 v[180:183], v[52:55], v[76:79], v[180:183]
    v_mfma_f32_16x16x32_bf16 v[184:187], v[56:59], v[76:79], v[184:187]
    v_mfma_f32_16x16x32_bf16 v[188:191], v[60:63], v[76:79], v[188:191]
    ds_read_b128 v[76:79], v4 offset:22528
    s_waitcnt lgkmcnt(5)
    v_mfma_f32_16x16x32_bf16 v[128:131], v[32:35], v[64:67], v[128:131]
    ds_read_b128 v[48:51], v3 offset:49152
    v_mfma_f32_16x16x32_bf16 v[132:135], v[36:39], v[64:67], v[132:135]
    ds_read_b128 v[52:55], v3 offset:51200
    s_waitcnt lgkmcnt(6)
    v_mfma_f32_16x16x32_bf16 v[136:139], v[40:43], v[64:67], v[136:139]
    s_waitcnt lgkmcnt(5)
    v_mfma_f32_16x16x32_bf16 v[140:143], v[44:47], v[64:67], v[140:143]
    ds_read_b128 v[64:67], v5 offset:16384
    s_waitcnt lgkmcnt(5)
    v_mfma_f32_16x16x32_bf16 v[144:147], v[32:35], v[68:71], v[144:147]
    ds_read_b128 v[56:59], v3 offset:53248
    v_mfma_f32_16x16x32_bf16 v[148:151], v[36:39], v[68:71], v[148:151]
    ds_read_b128 v[60:63], v3 offset:55296
    v_mfma_f32_16x16x32_bf16 v[152:155], v[40:43], v[68:71], v[152:155]
    v_mfma_f32_16x16x32_bf16 v[156:159], v[44:47], v[68:71], v[156:159]
    ds_read_b128 v[68:71], v5 offset:18432
    s_waitcnt lgkmcnt(7)
    v_mfma_f32_16x16x32_bf16 v[160:163], v[32:35], v[72:75], v[160:163]
    v_mfma_f32_16x16x32_bf16 v[164:167], v[36:39], v[72:75], v[164:167]
    v_mfma_f32_16x16x32_bf16 v[168:171], v[40:43], v[72:75], v[168:171]
    v_mfma_f32_16x16x32_bf16 v[172:175], v[44:47], v[72:75], v[172:175]
    ds_read_b128 v[72:75], v5 offset:20480
    s_waitcnt lgkmcnt(7)
    v_mfma_f32_16x16x32_bf16 v[176:179], v[32:35], v[76:79], v[176:179]
    v_mfma_f32_16x16x32_bf16 v[180:183], v[36:39], v[76:79], v[180:183]
    v_mfma_f32_16x16x32_bf16 v[184:187], v[40:43], v[76:79], v[184:187]
    v_mfma_f32_16x16x32_bf16 v[188:191], v[44:47], v[76:79], v[188:191]
    ds_read_b128 v[76:79], v5 offset:22528
    s_waitcnt lgkmcnt(5)
    v_mfma_f32_16x16x32_bf16 v[128:131], v[48:51], v[64:67], v[128:131]
    v_mfma_f32_16x16x32_bf16 v[132:135], v[52:55], v[64:67], v[132:135]
    s_waitcnt lgkmcnt(4)
    v_mfma_f32_16x16x32_bf16 v[136:139], v[56:59], v[64:67], v[136:139]
    s_waitcnt lgkmcnt(3)
    v_mfma_f32_16x16x32_bf16 v[140:143], v[60:63], v[64:67], v[140:143]
    s_waitcnt lgkmcnt(2)
    v_mfma_f32_16x16x32_bf16 v[144:147], v[48:51], v[68:71], v[144:147]
    v_mfma_f32_16x16x32_bf16 v[148:151], v[52:55], v[68:71], v[148:151]
    v_mfma_f32_16x16x32_bf16 v[152:155], v[56:59], v[68:71], v[152:155]
    v_mfma_f32_16x16x32_bf16 v[156:159], v[60:63], v[68:71], v[156:159]
    s_waitcnt lgkmcnt(1)
    v_mfma_f32_16x16x32_bf16 v[160:163], v[48:51], v[72:75], v[160:163]
    v_mfma_f32_16x16x32_bf16 v[164:167], v[52:55], v[72:75], v[164:167]
    v_mfma_f32_16x16x32_bf16 v[168:171], v[56:59], v[72:75], v[168:171]
    v_mfma_f32_16x16x32_bf16 v[172:175], v[60:63], v[72:75], v[172:175]
    s_waitcnt lgkmcnt(0)
    v_mfma_f32_16x16x32_bf16 v[176:179], v[48:51], v[76:79], v[176:179]
    v_mfma_f32_16x16x32_bf16 v[180:183], v[52:55], v[76:79], v[180:183]
    v_mfma_f32_16x16x32_bf16 v[184:187], v[56:59], v[76:79], v[184:187]
    v_mfma_f32_16x16x32_bf16 v[188:191], v[60:63], v[76:79], v[188:191]
    s_setprio 3
    v_mov_b32 v31, v29
    s_waitcnt vmcnt(0)
    v_mov_b64 v[92:93], v[100:101]
    s_mov_b32 s79, 0
L_tag0:
    v_readfirstlane_b32 s61, v93
    s_nop 0
    s_cmp_lg_u32 s61, 0
    s_cbranch_scc1 L_tag0ok
    global_load_dwordx2 v[92:93], v30, s[62:63] sc1
    s_waitcnt vmcnt(0)
    s_add_u32 s79, s79, 1
    s_cmp_lt_u32 s79, 2097152
    s_cbranch_scc1 L_tag0
L_tag0ok:
    v_readfirstlane_b32 s60, v92
    v_lshlrev_b32 v30, 4, v1
    v_pk_fma_f32 v[100:101], v[12:13], v[128:129], v[130:131] op_sel_hi:[0,1,1]
    v_pk_fma_f32 v[108:109], v[14:15], v[144:145], v[146:147] op_sel_hi:[0,1,1]
    v_pk_fma_f32 v[102:103], v[12:13], v[160:161], v[162:163] op_sel_hi:[0,1,1]
    v_pk_fma_f32 v[110:111], v[14:15], v[176:177], v[178:179] op_sel_hi:[0,1,1]
    v_pk_fma_f32 v[100:101], v[124:125], v[160:161], v[100:101] op_sel_hi:[0,1,1] neg_lo:[1,0,0] neg_hi:[1,0,0]
    v_pk_fma_f32 v[108:109], v[126:127], v[176:177], v[108:109] op_sel_hi:[0,1,1] neg_lo:[1,0,0] neg_hi:[1,0,0]
    v_pk_fma_f32 v[102:103], v[124:125], v[128:129], v[102:103] op_sel_hi:[0,1,1]
    v_pk_fma_f32 v[110:111], v[126:127], v[144:145], v[110:111] op_sel_hi:[0,1,1]
    v_pk_fma_f32 v[96:97], v[12:13], v[100:101], v[132:133] op_sel_hi:[0,1,1]
    v_pk_fma_f32 v[104:105], v[14:15], v[108:109], v[148:149] op_sel_hi:[0,1,1]
    v_pk_fma_f32 v[98:99], v[12:13], v[102:103], v[164:165] op_sel_hi:[0,1,1]
    v_pk_fma_f32 v[106:107], v[14:15], v[110:111], v[180:181] op_sel_hi:[0,1,1]
    v_pk_fma_f32 v[96:97], v[124:125], v[102:103], v[96:97] op_sel_hi:[0,1,1] neg_lo:[1,0,0] neg_hi:[1,0,0]
    v_pk_fma_f32 v[104:105], v[126:127], v[110:111], v[104:105] op_sel_hi:[0,1,1] neg_lo:[1,0,0] neg_hi:[1,0,0]
    v_pk_fma_f32 v[98:99], v[124:125], v[100:101], v[98:99] op_sel_hi:[0,1,1]
    v_pk_fma_f32 v[106:107], v[126:127], v[108:109], v[106:107] op_sel_hi:[0,1,1]
    v_pk_fma_f32 v[100:101], v[12:13], v[96:97], v[134:135] op_sel_hi:[0,1,1]
    v_pk_fma_f32 v[108:109], v[14:15], v[104:105], v[150:151] op_sel_hi:[0,1,1]
    v_pk_fma_f32 v[102:103], v[12:13], v[98:99], v[166:167] op_sel_hi:[0,1,1]
    v_pk_fma_f32 v[110:111], v[14:15], v[106:107], v[182:183] op_sel_hi:[0,1,1]
    v_pk_fma_f32 v[100:101], v[124:125], v[98:99], v[100:101] op_sel_hi:[0,1,1] neg_lo:[1,0,0] neg_hi:[1,0,0]
    v_pk_fma_f32 v[108:109], v[126:127], v[106:107], v[108:109] op_sel_hi:[0,1,1] neg_lo:[1,0,0] neg_hi:[1,0,0]
    v_pk_fma_f32 v[102:103], v[124:125], v[96:97], v[102:103] op_sel_hi:[0,1,1]
    v_pk_fma_f32 v[110:111], v[126:127], v[104:105], v[110:111] op_sel_hi:[0,1,1]
    v_pk_fma_f32 v[96:97], v[12:13], v[100:101], v[136:137] op_sel_hi:[0,1,1]
    v_pk_fma_f32 v[104:105], v[14:15], v[108:109], v[152:153] op_sel_hi:[0,1,1]
    v_pk_fma_f32 v[98:99], v[12:13], v[102:103], v[168:169] op_sel_hi:[0,1,1]
    v_pk_fma_f32 v[106:107], v[14:15], v[110:111], v[184:185] op_sel_hi:[0,1,1]
    v_pk_fma_f32 v[96:97], v[124:125], v[102:103], v[96:97] op_sel_hi:[0,1,1] neg_lo:[1,0,0] neg_hi:[1,0,0]
    v_pk_fma_f32 v[104:105], v[126:127], v[110:111], v[104:105] op_sel_hi:[0,1,1] neg_lo:[1,0,0] neg_hi:[1,0,0]
    v_pk_fma_f32 v[98:99], v[124:125], v[100:101], v[98:99] op_sel_hi:[0,1,1]
    v_pk_fma_f32 v[106:107], v[126:127], v[108:109], v[106:107] op_sel_hi:[0,1,1]
    v_pk_fma_f32 v[100:101], v[12:13], v[96:97], v[138:139] op_sel_hi:[0,1,1]
    v_pk_fma_f32 v[108:109], v[14:15], v[104:105], v[154:155] op_sel_hi:[0,1,1]
    v_pk_fma_f32 v[102:103], v[12:13], v[98:99], v[170:171] op_sel_hi:[0,1,1]
    v_pk_fma_f32 v[110:111], v[14:15], v[106:107], v[186:187] op_sel_hi:[0,1,1]
    v_pk_fma_f32 v[100:101], v[124:125], v[98:99], v[100:101] op_sel_hi:[0,1,1] neg_lo:[1,0,0] neg_hi:[1,0,0]
    v_pk_fma_f32 v[108:109], v[126:127], v[106:107], v[108:109] op_sel_hi:[0,1,1] neg_lo:[1,0,0] neg_hi:[1,0,0]
    v_pk_fma_f32 v[102:103], v[124:125], v[96:97], v[102:103] op_sel_hi:[0,1,1]
    v_pk_fma_f32 v[110:111], v[126:127], v[104:105], v[110:111] op_sel_hi:[0,1,1]
    v_pk_fma_f32 v[96:97], v[12:13], v[100:101], v[140:141] op_sel_hi:[0,1,1]
    v_pk_fma_f32 v[104:105], v[14:15], v[108:109], v[156:157] op_sel_hi:[0,1,1]
    v_pk_fma_f32 v[98:99], v[12:13], v[102:103], v[172:173] op_sel_hi:[0,1,1]
    v_pk_fma_f32 v[106:107], v[14:15], v[110:111], v[188:189] op_sel_hi:[0,1,1]
    v_pk_fma_f32 v[96:97], v[124:125], v[102:103], v[96:97] op_sel_hi:[0,1,1] neg_lo:[1,0,0] neg_hi:[1,0,0]
    v_pk_fma_f32 v[104:105], v[126:127], v[110:111], v[104:105] op_sel_hi:[0,1,1] neg_lo:[1,0,0] neg_hi:[1,0,0]
    v_pk_fma_f32 v[98:99], v[124:125], v[100:101], v[98:99] op_sel_hi:[0,1,1]
    v_pk_fma_f32 v[106:107], v[126:127], v[108:109], v[106:107] op_sel_hi:[0,1,1]
    v_pk_fma_f32 v[100:101], v[12:13], v[96:97], v[142:143] op_sel_hi:[0,1,1]
    v_pk_fma_f32 v[108:109], v[14:15], v[104:105], v[158:159] op_sel_hi:[0,1,1]
    v_pk_fma_f32 v[102:103], v[12:13], v[98:99], v[174:175] op_sel_hi:[0,1,1]
    v_pk_fma_f32 v[110:111], v[14:15], v[106:107], v[190:191] op_sel_hi:[0,1,1]
    v_pk_fma_f32 v[100:101], v[124:125], v[98:99], v[100:101] op_sel_hi:[0,1,1] neg_lo:[1,0,0] neg_hi:[1,0,0]
    v_pk_fma_f32 v[108:109], v[126:127], v[106:107], v[108:109] op_sel_hi:[0,1,1] neg_lo:[1,0,0] neg_hi:[1,0,0]
    v_pk_fma_f32 v[102:103], v[124:125], v[96:97], v[102:103] op_sel_hi:[0,1,1]
    v_pk_fma_f32 v[110:111], v[126:127], v[104:105], v[110:111] op_sel_hi:[0,1,1]
    v_fma_f32 v112, v8, v100, v101
    v_fma_f32 v113, v10, v108, v109
    v_fma_f32 v114, v8, v102, v103
    v_fma_f32 v115, v10, v110, v111
    v_fma_f32 v112, -v9, v102, v112
    v_fma_f32 v113, -v11, v110, v113
    v_fma_f32 v114, v9, v100, v114
    v_fma_f32 v115, v11, v108, v115
    s_lshl_b32 s74, s68, 10
    s_add_u32 s74, s74, 147456
    v_add_u32 v4, s74, v30
    v_permlane16_swap_b32 v112, v113
    v_permlane16_swap_b32 v114, v115
    ds_write_b128 v4, v[112:115]
    v_and_b32 v28, 0x1f0, v30
    v_add_u32 v29, 147456, v28
    v_mov_b64 v[12:13], v[120:121]
    v_mov_b64 v[14:15], v[122:123]
L_xch:
    ds_read_b128 v[96:99], v29 offset:0
    ds_read_b128 v[100:103], v29 offset:512
    ds_read_b128 v[104:107], v29 offset:1024
    ds_read_b128 v[108:111], v29 offset:1536
    s_waitcnt lgkmcnt(0)
    v_max3_u32 v4, v96, v100, v104
    v_max_u32 v4, v4, v108
    v_cmp_eq_u32 vcc, -1, v4
    s_add_u32 s79, s79, 1
    s_cbranch_vccz L_xchok
    s_cmp_lt_u32 s79, 2097152
    s_cbranch_scc1 L_xch
L_xchok:
    ds_read_b128 v[32:35], v2 offset:0
    ds_read_b128 v[36:39], v2 offset:2048
    ds_read_b128 v[40:43], v2 offset:4096
    ds_read_b128 v[44:47], v2 offset:6144
    ds_read_b64_tr_b16 v[64:65], v6 offset:24576
    ds_read_b64_tr_b16 v[66:67], v6 offset:24832
    ds_read_b64_tr_b16 v[68:69], v7 offset:24576
    ds_read_b64_tr_b16 v[70:71], v7 offset:24832
    ds_read_b64_tr_b16 v[72:73], v6 offset:36864
    ds_read_b64_tr_b16 v[74:75], v6 offset:37120
    ds_read_b64_tr_b16 v[76:77], v7 offset:36864
    ds_read_b64_tr_b16 v[78:79], v7 offset:37120
    v_fma_f32 v97, v22, v96, v97
    v_fma_f32 v99, v22, v98, v99
    v_fma_f32 v97, -v23, v98, v97
    v_fma_f32 v99, v23, v96, v99
    v_fma_f32 v100, v22, v97, v100
    v_fma_f32 v102, v22, v99, v102
    v_fma_f32 v100, -v23, v99, v100
    v_fma_f32 v102, v23, v97, v102
    v_fma_f32 v101, v22, v100, v101
    v_fma_f32 v103, v22, v102, v103
    v_fma_f32 v101, -v23, v102, v101
    v_fma_f32 v103, v23, v100, v103
    v_fma_f32 v104, v22, v101, v104
    v_fma_f32 v106, v22, v103, v106
    v_fma_f32 v104, -v23, v103, v104
    v_fma_f32 v106, v23, v101, v106
    v_fma_f32 v105, v22, v104, v105
    v_fma_f32 v107, v22, v106, v107
    v_fma_f32 v105, -v23, v106, v105
    v_fma_f32 v107, v23, v104, v107
    v_fma_f32 v108, v22, v105, v108
    v_fma_f32 v110, v22, v107, v110
    v_fma_f32 v108, -v23, v107, v108
    v_fma_f32 v110, v23, v105, v110
    v_fma_f32 v90, v22, v108, v109
    v_fma_f32 v91, v22, v110, v111
    v_fma_f32 v90, -v23, v110, v90
    v_fma_f32 v91, v23, v108, v91
    s_cmp_eq_u32 s64, 0
    s_cbranch_scc0 L_nopub
    s_lshl_b32 s74, s65, 9
    s_mov_b32 exec_hi, 0
    buffer_store_dwordx4 v[90:93], v28, s[28:31], s74 offen sc1
    s_mov_b64 exec, -1
L_nopub:
    v_lshrrev_b32 v22, 5, v1
    v_lshlrev_b32 v4, 9, v22
    s_lshl_b32 s74, s65, 9
    s_sub_u32 s74, s74, 512
    v_add_u32 v28, s74, v28
    v_sub_u32 v28, v28, v4
    v_sub_u32 v23, s65, v22
    s_lshl_b32 s74, s68, 1
    v_add_u32 v4, s74, v22
    v_mov_b32 v84, 0
    v_mov_b32 v86, 0
    v_mov_b32 v85, v96
    v_mov_b32 v87, v98
    v_cmp_eq_u32 vcc, 1, v4
    s_nop 1
    v_cndmask_b32 v84, v84, v97, vcc
    v_cndmask_b32 v86, v86, v99, vcc
    v_cndmask_b32 v85, v85, v100, vcc
    v_cndmask_b32 v87, v87, v102, vcc
    v_cmp_eq_u32 vcc, 2, v4
    s_nop 1
    v_cndmask_b32 v84, v84, v101, vcc
    v_cndmask_b32 v86, v86, v103, vcc
    v_cndmask_b32 v85, v85, v104, vcc
    v_cndmask_b32 v87, v87, v106, vcc
    v_cmp_eq_u32 vcc, 3, v4
    s_nop 1
    v_cndmask_b32 v84, v84, v105, vcc
    v_cndmask_b32 v86, v86, v107, vcc
    v_cndmask_b32 v85, v85, v108, vcc
    v_cndmask_b32 v87, v87, v110, vcc
    s_waitcnt lgkmcnt(6)
    v_mfma_f32_16x16x32_bf16 v[192:195], v[64:67], v[32:35], v[192:195]
    ds_read_b128 v[48:51], v3 offset:0
    v_mfma_f32_16x16x32_bf16 v[196:199], v[64:67], v[36:39], v[196:199]
    ds_read_b128 v[52:55], v3 offset:2048
    v_mfma_f32_16x16x32_bf16 v[200:203], v[64:67], v[40:43], v[200:203]
    v_mfma_f32_16x16x32_bf16 v[204:207], v[64:67], v[44:47], v[204:207]
    ds_read_b64_tr_b16 v[64:65], v6 offset:26624
    ds_read_b64_tr_b16 v[66:67], v6 offset:26880
    s_waitcnt lgkmcnt(8)
    v_mfma_f32_16x16x32_bf16 v[208:211], v[68:71], v[32:35], v[208:211]
    ds_read_b128 v[56:59], v3 offset:4096
    v_mfma_f32_16x16x32_bf16 v[212:215], v[68:71], v[36:39], v[212:215]
    ds_read_b128 v[60:63], v3 offset:6144
    v_mfma_f32_16x16x32_bf16 v[216:219], v[68:71], v[40:43], v[216:219]
    v_mfma_f32_16x16x32_bf16 v[220:223], v[68:71], v[44:47], v[220:223]
    ds_read_b64_tr_b16 v[68:69], v7 offset:26624
    ds_read_b64_tr_b16 v[70:71], v7 offset:26880
    s_waitcnt lgkmcnt(10)
    v_mfma_f32_16x16x32_bf16 v[224:227], v[72:75], v[32:35], v[224:227]
    v_mfma_f32_16x16x32_bf16 v[228:231], v[72:75], v[36:39], v[228:231]
    v_mfma_f32_16x16x32_bf16 v[232:235], v[72:75], v[40:43], v[232:235]
    v_mfma_f32_16x16x32_bf16 v[236:239], v[72:75], v[44:47], v[236:239]
    ds_read_b64_tr_b16 v[72:73], v6 offset:38912
    ds_read_b64_tr_b16 v[74:75], v6 offset:39168
    s_waitcnt lgkmcnt(10)
    v_mfma_f32_16x16x32_bf16 v[240:243], v[76:79], v[32:35], v[240:243]
    v_mfma_f32_16x16x32_bf16 v[244:247], v[76:79], v[36:39], v[244:247]
    v_mfma_f32_16x16x32_bf16 v[248:251], v[76:79], v[40:43], v[248:251]
    v_mfma_f32_16x16x32_bf16 v[252:255], v[76:79], v[44:47], v[252:255]
    ds_read_b64_tr_b16 v[76:77], v7 offset:38912
    ds_read_b64_tr_b16 v[78:79], v7 offset:39168
    v_add_u32 v6, 49152, v6
    v_add_u32 v7, 49152, v7
    s_waitcnt lgkmcnt(8)
    v_mfma_f32_16x16x32_bf16 v[192:195], v[64:67], v[48:51], v[192:195]
    ds_read_b128 v[32:35], v2 offset:49152
    v_mfma_f32_16x16x32_bf16 v[196:199], v[64:67], v[52:55], v[196:199]
    ds_read_b128 v[36:39], v2 offset:51200
    s_waitcnt lgkmcnt(9)
    v_mfma_f32_16x16x32_bf16 v[200:203], v[64:67], v[56:59], v[200:203]
    s_waitcnt lgkmcnt(8)
    v_mfma_f32_16x16x32_bf16 v[204:207], v[64:67], v[60:63], v[204:207]
    ds_read_b64_tr_b16 v[64:65], v6 offset:24576
    ds_read_b64_tr_b16 v[66:67], v6 offset:24832
    s_waitcnt lgkmcnt(8)
    v_mfma_f32_16x16x32_bf16 v[208:211], v[68:71], v[48:51], v[208:211]
    ds_read_b128 v[40:43], v2 offset:53248
    v_mfma_f32_16x16x32_bf16 v[212:215], v[68:71], v[52:55], v[212:215]
    ds_read_b128 v[44:47], v2 offset:55296
    v_mfma_f32_16x16x32_bf16 v[216:219], v[68:71], v[56:59], v[216:219]
    v_mfma_f32_16x16x32_bf16 v[220:223], v[68:71], v[60:63], v[220:223]
    ds_read_b64_tr_b16 v[68:69], v7 offset:24576
    ds_read_b64_tr_b16 v[70:71], v7 offset:24832
    s_waitcnt lgkmcnt(10)
    v_mfma_f32_16x16x32_bf16 v[224:227], v[72:75], v[48:51], v[224:227]
    v_mfma_f32_16x16x32_bf16 v[228:231], v[72:75], v[52:55], v[228:231]
    v_mfma_f32_16x16x32_bf16 v[232:235], v[72:75], v[56:59], v[232:235]
    v_mfma_f32_16x16x32_bf16 v[236:239], v[72:75], v[60:63], v[236:239]
    ds_read_b64_tr_b16 v[72:73], v6 offset:36864
    ds_read_b64_tr_b16 v[74:75], v6 offset:37120
    s_waitcnt lgkmcnt(10)
    v_mfma_f32_16x16x32_bf16 v[240:243], v[76:79], v[48:51], v[240:243]
    v_mfma_f32_16x16x32_bf16 v[244:247], v[76:79], v[52:55], v[244:247]
    v_mfma_f32_16x16x32_bf16 v[248:251], v[76:79], v[56:59], v[248:251]
    v_mfma_f32_16x16x32_bf16 v[252:255], v[76:79], v[60:63], v[252:255]
    ds_read_b64_tr_b16 v[76:77], v7 offset:36864
    ds_read_b64_tr_b16 v[78:79], v7 offset:37120
    s_waitcnt lgkmcnt(8)
    v_mfma_f32_16x16x32_bf16 v[192:195], v[64:67], v[32:35], v[192:195]
    ds_read_b128 v[48:51], v3 offset:49152
    v_mfma_f32_16x16x32_bf16 v[196:199], v[64:67], v[36:39], v[196:199]
    ds_read_b128 v[52:55], v3 offset:51200
    s_waitcnt lgkmcnt(9)
    v_mfma_f32_16x16x32_bf16 v[200:203], v[64:67], v[40:43], v[200:203]
    s_waitcnt lgkmcnt(8)
    v_mfma_f32_16x16x32_bf16 v[204:207], v[64:67], v[44:47], v[204:207]
    ds_read_b64_tr_b16 v[64:65], v6 offset:26624
    ds_read_b64_tr_b16 v[66:67], v6 offset:26880
    s_waitcnt lgkmcnt(8)
    v_mfma_f32_16x16x32_bf16 v[208:211], v[68:71], v[32:35], v[208:211]
    ds_read_b128 v[56:59], v3 offset:53248
    v_mfma_f32_16x16x32_bf16 v[212:215], v[68:71], v[36:39], v[212:215]
    ds_read_b128 v[60:63], v3 offset:55296
    v_mfma_f32_16x16x32_bf16 v[216:219], v[68:71], v[40:43], v[216:219]
    v_mfma_f32_16x16x32_bf16 v[220:223], v[68:71], v[44:47], v[220:223]
    ds_read_b64_tr_b16 v[68:69], v7 offset:26624
    ds_read_b64_tr_b16 v[70:71], v7 offset:26880
    s_waitcnt lgkmcnt(10)
    v_mfma_f32_16x16x32_bf16 v[224:227], v[72:75], v[32:35], v[224:227]
    v_mfma_f32_16x16x32_bf16 v[228:231], v[72:75], v[36:39], v[228:231]
    v_mfma_f32_16x16x32_bf16 v[232:235], v[72:75], v[40:43], v[232:235]
    v_mfma_f32_16x16x32_bf16 v[236:239], v[72:75], v[44:47], v[236:239]
    ds_read_b64_tr_b16 v[72:73], v6 offset:38912
    ds_read_b64_tr_b16 v[74:75], v6 offset:39168
    s_waitcnt lgkmcnt(10)
    v_mfma_f32_16x16x32_bf16 v[240:243], v[76:79], v[32:35], v[240:243]
    v_mfma_f32_16x16x32_bf16 v[244:247], v[76:79], v[36:39], v[244:247]
    v_mfma_f32_16x16x32_bf16 v[248:251], v[76:79], v[40:43], v[248:251]
    v_mfma_f32_16x16x32_bf16 v[252:255], v[76:79], v[44:47], v[252:255]
    ds_read_b64_tr_b16 v[76:77], v7 offset:38912
    ds_read_b64_tr_b16 v[78:79], v7 offset:39168
    s_waitcnt lgkmcnt(8)
    v_mfma_f32_16x16x32_bf16 v[192:195], v[64:67], v[48:51], v[192:195]
    v_mfma_f32_16x16x32_bf16 v[196:199], v[64:67], v[52:55], v[196:199]
    s_waitcnt lgkmcnt(7)
    v_mfma_f32_16x16x32_bf16 v[200:203], v[64:67], v[56:59], v[200:203]
    s_waitcnt lgkmcnt(6)
    v_mfma_f32_16x16x32_bf16 v[204:207], v[64:67], v[60:63], v[204:207]
    s_waitcnt lgkmcnt(4)
    v_mfma_f32_16x16x32_bf16 v[208:211], v[68:71], v[48:51], v[208:211]
    v_mfma_f32_16x16x32_bf16 v[212:215], v[68:71], v[52:55], v[212:215]
    v_mfma_f32_16x16x32_bf16 v[216:219], v[68:71], v[56:59], v[216:219]
    v_mfma_f32_16x16x32_bf16 v[220:223], v[68:71], v[60:63], v[220:223]
    s_waitcnt lgkmcnt(2)
    v_mfma_f32_16x16x32_bf16 v[224:227], v[72:75], v[48:51], v[224:227]
    v_mfma_f32_16x16x32_bf16 v[228:231], v[72:75], v[52:55], v[228:231]
    v_mfma_f32_16x16x32_bf16 v[232:235], v[72:75], v[56:59], v[232:235]
    v_mfma_f32_16x16x32_bf16 v[236:239], v[72:75], v[60:63], v[236:239]
    s_waitcnt lgkmcnt(0)
    v_mfma_f32_16x16x32_bf16 v[240:243], v[76:79], v[48:51], v[240:243]
    v_mfma_f32_16x16x32_bf16 v[244:247], v[76:79], v[52:55], v[244:247]
    v_mfma_f32_16x16x32_bf16 v[248:251], v[76:79], v[56:59], v[248:251]
    v_mfma_f32_16x16x32_bf16 v[252:255], v[76:79], v[60:63], v[252:255]
    v_mov_b32 v5, 1
    ds_write_b32 v31, v5
    v_subrev_u32 v29, 0, v28
    buffer_load_dwordx4 v[96:99], v29, s[28:31], 0 offen sc1
    v_subrev_u32 v29, 1024, v28
    buffer_load_dwordx4 v[100:103], v29, s[28:31], 0 offen sc1
    v_subrev_u32 v29, 2048, v28
    buffer_load_dwordx4 v[104:107], v29, s[28:31], 0 offen sc1
    v_subrev_u32 v29, 3072, v28
    buffer_load_dwordx4 v[108:111], v29, s[28:31], 0 offen sc1
    v_subrev_u32 v29, 4096, v28
    buffer_load_dwordx4 v[112:115], v29, s[28:31], 0 offen sc1
    v_subrev_u32 v29, 5120, v28
    buffer_load_dwordx4 v[116:119], v29, s[28:31], 0 offen sc1
    v_subrev_u32 v29, 6144, v28
    buffer_load_dwordx4 v[120:123], v29, s[28:31], 0 offen sc1
    v_subrev_u32 v29, 7168, v28
    buffer_load_dwordx4 v[124:127], v29, s[28:31], 0 offen sc1
    s_lshl_b32 s74, s65, 1
    s_add_u32 s77, s74, s68
    s_mul_i32 s74, s77, 307200
    v_lshl_add_u32 v2, v1, 4, s74
    v_and_b32 v3, 15, v1
    v_lshl_add_u32 v3, v3, 4, s74
    v_bfe_u32 v6, v1, 4, 1
    v_lshl_add_u32 v3, v6, 9, v3
    v_lshrrev_b32 v6, 5, v1
    v_lshl_add_u32 v3, v6, 11, v3
    s_lshl_b32 s77, s77, 13
    s_lshl_b32 s74, s66, 9
    s_add_u32 s77, s77, s74
    s_add_u32 s77, s77, 10747904
    s_add_u32 s74, s67, 32
    s_lshl_b32 s74, s74, 12
    v_pk_mul_f32 v[192:193], v[192:193], v[224:225]
    v_pk_mul_f32 v[194:195], v[194:195], v[226:227]
    v_pk_mul_f32 v[208:209], v[208:209], v[240:241]
    v_pk_mul_f32 v[210:211], v[210:211], v[242:243]
    v_cvt_pk_bf16_f32 v32, v192, v193
    v_cvt_pk_bf16_f32 v33, v194, v195
    v_cvt_pk_bf16_f32 v34, v208, v209
    v_cvt_pk_bf16_f32 v35, v210, v211
    buffer_store_dwordx4 v[32:35], v3, s[24:27], s74 offen offset:0 sc1
    v_pk_mul_f32 v[196:197], v[196:197], v[228:229]
    v_pk_mul_f32 v[198:199], v[198:199], v[230:231]
    v_pk_mul_f32 v[212:213], v[212:213], v[244:245]
    v_pk_mul_f32 v[214:215], v[214:215], v[246:247]
    v_cvt_pk_bf16_f32 v36, v196, v197
    v_cvt_pk_bf16_f32 v37, v198, v199
    v_cvt_pk_bf16_f32 v38, v212, v213
    v_cvt_pk_bf16_f32 v39, v214, v215
    buffer_store_dwordx4 v[36:39], v3, s[24:27], s74 offen offset:256 sc1
    v_pk_mul_f32 v[200:201], v[200:201], v[232:233]
    v_pk_mul_f32 v[202:203], v[202:203], v[234:235]
    v_pk_mul_f32 v[216:217], v[216:217], v[248:249]
    v_pk_mul_f32 v[218:219], v[218:219], v[250:251]
    v_cvt_pk_bf16_f32 v40, v200, v201
    v_cvt_pk_bf16_f32 v41, v202, v203
    v_cvt_pk_bf16_f32 v42, v216, v217
    v_cvt_pk_bf16_f32 v43, v218, v219
    buffer_store_dwordx4 v[40:43], v3, s[24:27], s74 offen offset:1024 sc1
    v_pk_mul_f32 v[204:205], v[204:205], v[236:237]
    v_pk_mul_f32 v[206:207], v[206:207], v[238:239]
    v_pk_mul_f32 v[220:221], v[220:221], v[252:253]
    v_pk_mul_f32 v[222:223], v[222:223], v[254:255]
    v_cvt_pk_bf16_f32 v44, v204, v205
    v_cvt_pk_bf16_f32 v45, v206, v207
    v_cvt_pk_bf16_f32 v46, v220, v221
    v_cvt_pk_bf16_f32 v47, v222, v223
    buffer_store_dwordx4 v[44:47], v3, s[24:27], s74 offen offset:1280 sc1
    v_mov_b32 v72, v17
    v_pk_mul_f32 v[68:69], v[72:73], v[160:161] op_sel_hi:[0,1]
    v_pk_mul_f32 v[70:71], v[72:73], v[128:129] op_sel_hi:[0,1]
    v_pk_fma_f32 v[128:129], v[16:17], v[128:129], v[68:69] op_sel_hi:[0,1,1] neg_lo:[0,0,1] neg_hi:[0,0,1]
    v_pk_fma_f32 v[160:161], v[16:17], v[160:161], v[70:71] op_sel_hi:[0,1,1]
    v_pk_mul_f32 v[68:69], v[72:73], v[162:163] op_sel_hi:[0,1]
    v_pk_mul_f32 v[70:71], v[72:73], v[130:131] op_sel_hi:[0,1]
    v_pk_fma_f32 v[130:131], v[16:17], v[130:131], v[68:69] op_sel_hi:[0,1,1] neg_lo:[0,0,1] neg_hi:[0,0,1]
    v_pk_fma_f32 v[162:163], v[16:17], v[162:163], v[70:71] op_sel_hi:[0,1,1]
    v_pk_mul_f32 v[68:69], v[72:73], v[164:165] op_sel_hi:[0,1]
    v_pk_mul_f32 v[70:71], v[72:73], v[132:133] op_sel_hi:[0,1]
    v_pk_fma_f32 v[132:133], v[16:17], v[132:133], v[68:69] op_sel_hi:[0,1,1] neg_lo:[0,0,1] neg_hi:[0,0,1]
    v_pk_fma_f32 v[164:165], v[16:17], v[164:165], v[70:71] op_sel_hi:[0,1,1]
    v_pk_mul_f32 v[68:69], v[72:73], v[166:167] op_sel_hi:[0,1]
    v_pk_mul_f32 v[70:71], v[72:73], v[134:135] op_sel_hi:[0,1]
    v_pk_fma_f32 v[134:135], v[16:17], v[134:135], v[68:69] op_sel_hi:[0,1,1] neg_lo:[0,0,1] neg_hi:[0,0,1]
    v_pk_fma_f32 v[166:167], v[16:17], v[166:167], v[70:71] op_sel_hi:[0,1,1]
    v_pk_mul_f32 v[68:69], v[72:73], v[168:169] op_sel_hi:[0,1]
    v_pk_mul_f32 v[70:71], v[72:73], v[136:137] op_sel_hi:[0,1]
    v_pk_fma_f32 v[136:137], v[16:17], v[136:137], v[68:69] op_sel_hi:[0,1,1] neg_lo:[0,0,1] neg_hi:[0,0,1]
    v_pk_fma_f32 v[168:169], v[16:17], v[168:169], v[70:71] op_sel_hi:[0,1,1]
    v_pk_mul_f32 v[68:69], v[72:73], v[170:171] op_sel_hi:[0,1]
    v_pk_mul_f32 v[70:71], v[72:73], v[138:139] op_sel_hi:[0,1]
    v_pk_fma_f32 v[138:139], v[16:17], v[138:139], v[68:69] op_sel_hi:[0,1,1] neg_lo:[0,0,1] neg_hi:[0,0,1]
    v_pk_fma_f32 v[170:171], v[16:17], v[170:171], v[70:71] op_sel_hi:[0,1,1]
    v_pk_mul_f32 v[68:69], v[72:73], v[172:173] op_sel_hi:[0,1]
    v_pk_mul_f32 v[70:71], v[72:73], v[140:141] op_sel_hi:[0,1]
    v_pk_fma_f32 v[140:141], v[16:17], v[140:141], v[68:69] op_sel_hi:[0,1,1] neg_lo:[0,0,1] neg_hi:[0,0,1]
    v_pk_fma_f32 v[172:173], v[16:17], v[172:173], v[70:71] op_sel_hi:[0,1,1]
    v_pk_mul_f32 v[68:69], v[72:73], v[174:175] op_sel_hi:[0,1]
    v_pk_mul_f32 v[70:71], v[72:73], v[142:143] op_sel_hi:[0,1]
    v_pk_fma_f32 v[142:143], v[16:17], v[142:143], v[68:69] op_sel_hi:[0,1,1] neg_lo:[0,0,1] neg_hi:[0,0,1]
    v_pk_fma_f32 v[174:175], v[16:17], v[174:175], v[70:71] op_sel_hi:[0,1,1]
    v_mov_b32 v72, v19
    v_pk_mul_f32 v[68:69], v[72:73], v[176:177] op_sel_hi:[0,1]
    v_pk_mul_f32 v[70:71], v[72:73], v[144:145] op_sel_hi:[0,1]
    v_pk_fma_f32 v[144:145], v[18:19], v[144:145], v[68:69] op_sel_hi:[0,1,1] neg_lo:[0,0,1] neg_hi:[0,0,1]
    v_pk_fma_f32 v[176:177], v[18:19], v[176:177], v[70:71] op_sel_hi:[0,1,1]
    v_pk_mul_f32 v[68:69], v[72:73], v[178:179] op_sel_hi:[0,1]
    v_pk_mul_f32 v[70:71], v[72:73], v[146:147] op_sel_hi:[0,1]
    v_pk_fma_f32 v[146:147], v[18:19], v[146:147], v[68:69] op_sel_hi:[0,1,1] neg_lo:[0,0,1] neg_hi:[0,0,1]
    v_pk_fma_f32 v[178:179], v[18:19], v[178:179], v[70:71] op_sel_hi:[0,1,1]
    v_pk_mul_f32 v[68:69], v[72:73], v[180:181] op_sel_hi:[0,1]
    v_pk_mul_f32 v[70:71], v[72:73], v[148:149] op_sel_hi:[0,1]
    v_pk_fma_f32 v[148:149], v[18:19], v[148:149], v[68:69] op_sel_hi:[0,1,1] neg_lo:[0,0,1] neg_hi:[0,0,1]
    v_pk_fma_f32 v[180:181], v[18:19], v[180:181], v[70:71] op_sel_hi:[0,1,1]
    v_pk_mul_f32 v[68:69], v[72:73], v[182:183] op_sel_hi:[0,1]
    v_pk_mul_f32 v[70:71], v[72:73], v[150:151] op_sel_hi:[0,1]
    v_pk_fma_f32 v[150:151], v[18:19], v[150:151], v[68:69] op_sel_hi:[0,1,1] neg_lo:[0,0,1] neg_hi:[0,0,1]
    v_pk_fma_f32 v[182:183], v[18:19], v[182:183], v[70:71] op_sel_hi:[0,1,1]
    v_pk_mul_f32 v[68:69], v[72:73], v[184:185] op_sel_hi:[0,1]
    v_pk_mul_f32 v[70:71], v[72:73], v[152:153] op_sel_hi:[0,1]
    v_pk_fma_f32 v[152:153], v[18:19], v[152:153], v[68:69] op_sel_hi:[0,1,1] neg_lo:[0,0,1] neg_hi:[0,0,1]
    v_pk_fma_f32 v[184:185], v[18:19], v[184:185], v[70:71] op_sel_hi:[0,1,1]
    v_pk_mul_f32 v[68:69], v[72:73], v[186:187] op_sel_hi:[0,1]
    v_pk_mul_f32 v[70:71], v[72:73], v[154:155] op_sel_hi:[0,1]
    v_pk_fma_f32 v[154:155], v[18:19], v[154:155], v[68:69] op_sel_hi:[0,1,1] neg_lo:[0,0,1] neg_hi:[0,0,1]
    v_pk_fma_f32 v[186:187], v[18:19], v[186:187], v[70:71] op_sel_hi:[0,1,1]
    v_pk_mul_f32 v[68:69], v[72:73], v[188:189] op_sel_hi:[0,1]
    v_pk_mul_f32 v[70:71], v[72:73], v[156:157] op_sel_hi:[0,1]
    v_pk_fma_f32 v[156:157], v[18:19], v[156:157], v[68:69] op_sel_hi:[0,1,1] neg_lo:[0,0,1] neg_hi:[0,0,1]
    v_pk_fma_f32 v[188:189], v[18:19], v[188:189], v[70:71] op_sel_hi:[0,1,1]
    v_pk_mul_f32 v[68:69], v[72:73], v[190:191] op_sel_hi:[0,1]
    v_pk_mul_f32 v[70:71], v[72:73], v[158:159] op_sel_hi:[0,1]
    v_pk_fma_f32 v[158:159], v[18:19], v[158:159], v[68:69] op_sel_hi:[0,1,1] neg_lo:[0,0,1] neg_hi:[0,0,1]
    v_pk_fma_f32 v[190:191], v[18:19], v[190:191], v[70:71] op_sel_hi:[0,1,1]
    s_mov_b32 s50, 1
    s_waitcnt vmcnt(4)
    s_branch L_chk
L_poll:
    v_subrev_u32 v29, 0, v28
    buffer_load_dwordx4 v[96:99], v29, s[28:31], 0 offen sc1
    v_subrev_u32 v29, 1024, v28
    buffer_load_dwordx4 v[100:103], v29, s[28:31], 0 offen sc1
    v_subrev_u32 v29, 2048, v28
    buffer_load_dwordx4 v[104:107], v29, s[28:31], 0 offen sc1
    v_subrev_u32 v29, 3072, v28
    buffer_load_dwordx4 v[108:111], v29, s[28:31], 0 offen sc1
    v_subrev_u32 v29, 4096, v28
    buffer_load_dwordx4 v[112:115], v29, s[28:31], 0 offen sc1
    v_subrev_u32 v29, 5120, v28
    buffer_load_dwordx4 v[116:119], v29, s[28:31], 0 offen sc1
    v_subrev_u32 v29, 6144, v28
    buffer_load_dwordx4 v[120:123], v29, s[28:31], 0 offen sc1
    v_subrev_u32 v29, 7168, v28
    buffer_load_dwordx4 v[124:127], v29, s[28:31], 0 offen sc1
    s_cmp_eq_u32 s50, 0
    s_cbranch_scc1 L_nofl
    s_mov_b32 s50, 0
    s_waitcnt vmcnt(8)
    s_mov_b64 exec, 0xff
    buffer_store_dwordx4 v[92:95], v30, s[24:27], s77 offen sc1
    s_mov_b64 exec, -1
    s_waitcnt vmcnt(1)
    s_branch L_chk
L_nofl:
    s_waitcnt vmcnt(0)
L_chk:
    s_mov_b64 s[48:49], 0
    v_cmpx_lt_i32 vcc, 0, v23
    v_cmp_ne_u64 vcc, s[60:61], v[98:99]
    s_nop 0
    s_or_b64 s[48:49], s[48:49], vcc
    v_cmpx_lt_i32 vcc, 2, v23
    v_cmp_ne_u64 vcc, s[60:61], v[102:103]
    s_nop 0
    s_or_b64 s[48:49], s[48:49], vcc
    v_cmpx_lt_i32 vcc, 4, v23
    v_cmp_ne_u64 vcc, s[60:61], v[106:107]
    s_nop 0
    s_or_b64 s[48:49], s[48:49], vcc
    v_cmpx_lt_i32 vcc, 6, v23
    v_cmp_ne_u64 vcc, s[60:61], v[110:111]
    s_nop 0
    s_or_b64 s[48:49], s[48:49], vcc
    v_cmpx_lt_i32 vcc, 8, v23
    v_cmp_ne_u64 vcc, s[60:61], v[114:115]
    s_nop 0
    s_or_b64 s[48:49], s[48:49], vcc
    v_cmpx_lt_i32 vcc, 10, v23
    v_cmp_ne_u64 vcc, s[60:61], v[118:119]
    s_nop 0
    s_or_b64 s[48:49], s[48:49], vcc
    v_cmpx_lt_i32 vcc, 12, v23
    v_cmp_ne_u64 vcc, s[60:61], v[122:123]
    s_nop 0
    s_or_b64 s[48:49], s[48:49], vcc
    v_cmpx_lt_i32 vcc, 14, v23
    v_cmp_ne_u64 vcc, s[60:61], v[126:127]
    s_nop 0
    s_or_b64 s[48:49], s[48:49], vcc
    s_mov_b64 exec, -1
    s_cbranch_scc0 L_pollok
    s_add_u32 s79, s79, 1
    s_cmp_lt_u32 s79, 2097152
    s_cbranch_scc1 L_poll
L_pollok:
    v_fma_f32 v120, v26, v124, v120
    v_fma_f32 v121, v26, v125, v121
    v_fma_f32 v120, -v27, v125, v120
    v_fma_f32 v121, v27, v124, v121
    v_fma_f32 v116, v26, v120, v116
    v_fma_f32 v117, v26, v121, v117
    v_fma_f32 v116, -v27, v121, v116
    v_fma_f32 v117, v27, v120, v117
    v_fma_f32 v112, v26, v116, v112
    v_fma_f32 v113, v26, v117, v113
    v_fma_f32 v112, -v27, v117, v112
    v_fma_f32 v113, v27, v116, v113
    v_fma_f32 v108, v26, v112, v108
    v_fma_f32 v109, v26, v113, v109
    v_fma_f32 v108, -v27, v113, v108
    v_fma_f32 v109, v27, v112, v109
    v_fma_f32 v104, v26, v108, v104
    v_fma_f32 v105, v26, v109, v105
    v_fma_f32 v104, -v27, v109, v104
    v_fma_f32 v105, v27, v108, v105
    v_fma_f32 v100, v26, v104, v100
    v_fma_f32 v101, v26, v105, v101
    v_fma_f32 v100, -v27, v105, v100
    v_fma_f32 v101, v27, v104, v101
    v_fma_f32 v96, v26, v100, v96
    v_fma_f32 v97, v26, v101, v97
    v_fma_f32 v96, -v27, v101, v96
    v_fma_f32 v97, v27, v100, v97
    v_mov_b64 v[98:99], v[96:97]
    s_nop 1
    v_permlane32_swap_b32 v96, v98
    v_permlane32_swap_b32 v97, v99
    v_fma_f32 v96, v24, v98, v96
    v_fma_f32 v97, v24, v99, v97
    v_fma_f32 v96, -v25, v99, v96
    v_fma_f32 v97, v25, v98, v97
    v_mov_b32 v98, v97
    v_pk_fma_f32 v[84:85], v[96:97], v[12:13], v[84:85] op_sel_hi:[0,1,1]
    v_pk_fma_f32 v[86:87], v[96:97], v[14:15], v[86:87] op_sel_hi:[0,1,1]
    v_pk_fma_f32 v[84:85], v[98:99], v[14:15], v[84:85] op_sel_hi:[0,1,1] neg_lo:[1,0,0] neg_hi:[1,0,0]
    v_pk_fma_f32 v[86:87], v[98:99], v[12:13], v[86:87] op_sel_hi:[0,1,1]
    s_nop 0
    v_permlane16_swap_b32 v84, v85
    v_permlane16_swap_b32 v86, v87
    v_mul_f32 v68, v16, v84
    v_mul_f32 v69, v18, v85
    v_mul_f32 v70, v16, v86
    v_mul_f32 v71, v18, v87
    v_fma_f32 v68, -v17, v86, v68
    v_fma_f32 v69, -v19, v87, v69
    v_fma_f32 v70, v17, v84, v70
    v_fma_f32 v71, v19, v85, v71
    v_fmac_f32 v128, v8, v68
    v_fmac_f32 v144, v10, v69
    v_fmac_f32 v160, v8, v70
    v_fmac_f32 v176, v10, v71
    v_fmac_f32 v128, v20, v70
    v_fmac_f32 v144, v21, v71
    v_fmac_f32 v160, v9, v68
    v_fmac_f32 v176, v11, v69
    v_fmac_f32 v129, v8, v128
    v_fmac_f32 v145, v10, v144
    v_fmac_f32 v161, v8, v160
    v_fmac_f32 v177, v10, v176
    v_fmac_f32 v129, v20, v160
    v_fmac_f32 v145, v21, v176
    v_fmac_f32 v161, v9, v128
    v_fmac_f32 v177, v11, v144
    v_fmac_f32 v130, v8, v129
    v_fmac_f32 v146, v10, v145
    v_fmac_f32 v162, v8, v161
    v_fmac_f32 v178, v10, v177
    v_fmac_f32 v130, v20, v161
    v_fmac_f32 v146, v21, v177
    v_fmac_f32 v162, v9, v129
    v_fmac_f32 v178, v11, v145
    v_fmac_f32 v131, v8, v130
    v_fmac_f32 v147, v10, v146
    v_fmac_f32 v163, v8, v162
    v_fmac_f32 v179, v10, v178
    v_fmac_f32 v131, v20, v162
    v_fmac_f32 v147, v21, v178
    v_fmac_f32 v163, v9, v130
    v_fmac_f32 v179, v11, v146
    v_fmac_f32 v132, v8, v131
    v_fmac_f32 v148, v10, v147
    v_fmac_f32 v164, v8, v163
    v_fmac_f32 v180, v10, v179
    v_fmac_f32 v132, v20, v163
    v_fmac_f32 v148, v21, v179
    v_fmac_f32 v164, v9, v131
    v_fmac_f32 v180, v11, v147
    v_fmac_f32 v133, v8, v132
    v_fmac_f32 v149, v10, v148
    v_fmac_f32 v165, v8, v164
    v_fmac_f32 v181, v10, v180
    v_fmac_f32 v133, v20, v164
    v_fmac_f32 v149, v21, v180
    v_fmac_f32 v165, v9, v132
    v_fmac_f32 v181, v11, v148
    v_fmac_f32 v134, v8, v133
    v_fmac_f32 v150, v10, v149
    v_fmac_f32 v166, v8, v165
    v_fmac_f32 v182, v10, v181
    v_fmac_f32 v134, v20, v165
    v_fmac_f32 v150, v21, v181
    v_fmac_f32 v166, v9, v133
    v_fmac_f32 v182, v11, v149
    v_fmac_f32 v135, v8, v134
    v_fmac_f32 v151, v10, v150
    v_fmac_f32 v167, v8, v166
    v_fmac_f32 v183, v10, v182
    v_fmac_f32 v135, v20, v166
    v_fmac_f32 v151, v21, v182
    v_fmac_f32 v167, v9, v134
    v_fmac_f32 v183, v11, v150
    v_fmac_f32 v136, v8, v135
    v_fmac_f32 v152, v10, v151
    v_fmac_f32 v168, v8, v167
    v_fmac_f32 v184, v10, v183
    v_fmac_f32 v136, v20, v167
    v_fmac_f32 v152, v21, v183
    v_fmac_f32 v168, v9, v135
    v_fmac_f32 v184, v11, v151
    v_fmac_f32 v137, v8, v136
    v_fmac_f32 v153, v10, v152
    v_fmac_f32 v169, v8, v168
    v_fmac_f32 v185, v10, v184
    v_fmac_f32 v137, v20, v168
    v_fmac_f32 v153, v21, v184
    v_fmac_f32 v169, v9, v136
    v_fmac_f32 v185, v11, v152
    v_fmac_f32 v138, v8, v137
    v_fmac_f32 v154, v10, v153
    v_fmac_f32 v170, v8, v169
    v_fmac_f32 v186, v10, v185
    v_fmac_f32 v138, v20, v169
    v_fmac_f32 v154, v21, v185
    v_fmac_f32 v170, v9, v137
    v_fmac_f32 v186, v11, v153
    v_fmac_f32 v139, v8, v138
    v_fmac_f32 v155, v10, v154
    v_fmac_f32 v171, v8, v170
    v_fmac_f32 v187, v10, v186
    v_fmac_f32 v139, v20, v170
    v_fmac_f32 v155, v21, v186
    v_fmac_f32 v171, v9, v138
    v_fmac_f32 v187, v11, v154
    v_fmac_f32 v140, v8, v139
    v_fmac_f32 v156, v10, v155
    v_fmac_f32 v172, v8, v171
    v_fmac_f32 v188, v10, v187
    v_fmac_f32 v140, v20, v171
    v_fmac_f32 v156, v21, v187
    v_fmac_f32 v172, v9, v139
    v_fmac_f32 v188, v11, v155
    v_fmac_f32 v141, v8, v140
    v_fmac_f32 v157, v10, v156
    v_fmac_f32 v173, v8, v172
    v_fmac_f32 v189, v10, v188
    v_fmac_f32 v141, v20, v172
    v_fmac_f32 v157, v21, v188
    v_fmac_f32 v173, v9, v140
    v_fmac_f32 v189, v11, v156
    v_fmac_f32 v142, v8, v141
    v_fmac_f32 v158, v10, v157
    v_fmac_f32 v174, v8, v173
    v_fmac_f32 v190, v10, v189
    v_fmac_f32 v142, v20, v173
    v_fmac_f32 v158, v21, v189
    v_fmac_f32 v174, v9, v141
    v_fmac_f32 v190, v11, v157
    v_fmac_f32 v143, v8, v142
    v_fmac_f32 v159, v10, v158
    v_fmac_f32 v175, v8, v174
    v_fmac_f32 v191, v10, v190
    v_fmac_f32 v143, v20, v174
    v_fmac_f32 v159, v21, v190
    v_fmac_f32 v175, v9, v142
    v_fmac_f32 v191, v11, v158
    s_cmp_eq_u32 s50, 0
    s_cbranch_scc1 L_nof2
    s_mov_b32 s50, 0
    s_waitcnt vmcnt(0)
    s_mov_b64 exec, 0xff
    buffer_store_dwordx4 v[92:95], v30, s[24:27], s77 offen sc1
    s_mov_b64 exec, -1
L_nof2:
    v_cvt_pk_bf16_f32 v32, v128, v129
    v_cvt_pk_bf16_f32 v33, v130, v131
    v_cvt_pk_bf16_f32 v34, v132, v133
    v_cvt_pk_bf16_f32 v35, v134, v135
    v_cvt_pk_bf16_f32 v36, v136, v137
    v_cvt_pk_bf16_f32 v37, v138, v139
    v_cvt_pk_bf16_f32 v38, v140, v141
    v_cvt_pk_bf16_f32 v39, v142, v143
    v_cvt_pk_bf16_f32 v40, v144, v145
    v_cvt_pk_bf16_f32 v41, v146, v147
    v_cvt_pk_bf16_f32 v42, v148, v149
    v_cvt_pk_bf16_f32 v43, v150, v151
    v_cvt_pk_bf16_f32 v44, v152, v153
    v_cvt_pk_bf16_f32 v45, v154, v155
    v_cvt_pk_bf16_f32 v46, v156, v157
    v_cvt_pk_bf16_f32 v47, v158, v159
    s_mul_i32 s74, s68, 4608
    s_add_u32 s74, s74, 151552
    v_and_b32 v6, 15, v1
    v_mul_u32_u24 v6, 72, v6
    v_lshrrev_b32 v7, 4, v1
    v_lshl_add_u32 v6, v7, 3, v6
    v_add_u32 v6, s74, v6
    v_bfe_u32 v7, v1, 2, 2
    v_lshl_add_u32 v7, v22, 3, v7
    v_mul_u32_u24 v7, 72, v7
    v_bfe_u32 v8, v1, 4, 1
    v_lshl_add_u32 v7, v8, 5, v7
    v_and_b32 v8, 3, v1
    v_lshl_add_u32 v7, v8, 3, v7
    v_add_u32 v7, s74, v7
    s_lshr_b32 s74, s66, 2
    s_lshl_b32 s74, s74, 4
    s_and_b32 s75, s66, 3
    s_lshl_b32 s75, s75, 1
    s_add_u32 s74, s74, s75
    s_lshl_b32 s74, s74, 11
    s_add_u32 s75, s74, 16384
    ds_write_b64 v6, v[32:33] offset:0
    ds_write_b64 v6, v[34:35] offset:32
    ds_write_b64 v6, v[36:37] offset:2304
    ds_write_b64 v6, v[38:39] offset:2336
    ds_write_b64 v6, v[40:41] offset:1152
    ds_write_b64 v6, v[42:43] offset:1184
    ds_write_b64 v6, v[44:45] offset:3456
    ds_write_b64 v6, v[46:47] offset:3488
    ds_read_b64_tr_b16 v[96:97], v7 offset:0
    ds_read_b64_tr_b16 v[98:99], v7 offset:288
    ds_read_b64_tr_b16 v[100:101], v7 offset:1152
    ds_read_b64_tr_b16 v[102:103], v7 offset:1440
    ds_read_b64_tr_b16 v[104:105], v7 offset:2304
    ds_read_b64_tr_b16 v[106:107], v7 offset:2592
    ds_read_b64_tr_b16 v[108:109], v7 offset:3456
    ds_read_b64_tr_b16 v[110:111], v7 offset:3744
    v_cvt_pk_bf16_f32 v48, -v160, -v161
    v_cvt_pk_bf16_f32 v49, -v162, -v163
    v_cvt_pk_bf16_f32 v50, -v164, -v165
    v_cvt_pk_bf16_f32 v51, -v166, -v167
    v_cvt_pk_bf16_f32 v52, -v168, -v169
    v_cvt_pk_bf16_f32 v53, -v170, -v171
    v_cvt_pk_bf16_f32 v54, -v172, -v173
    v_cvt_pk_bf16_f32 v55, -v174, -v175
    v_cvt_pk_bf16_f32 v56, -v176, -v177
    v_cvt_pk_bf16_f32 v57, -v178, -v179
    v_cvt_pk_bf16_f32 v58, -v180, -v181
    v_cvt_pk_bf16_f32 v59, -v182, -v183
    v_cvt_pk_bf16_f32 v60, -v184, -v185
    v_cvt_pk_bf16_f32 v61, -v186, -v187
    v_cvt_pk_bf16_f32 v62, -v188, -v189
    v_cvt_pk_bf16_f32 v63, -v190, -v191
    s_waitcnt lgkmcnt(0)
    ds_write_b64 v6, v[48:49] offset:0
    ds_write_b64 v6, v[50:51] offset:32
    ds_write_b64 v6, v[52:53] offset:2304
    ds_write_b64 v6, v[54:55] offset:2336
    ds_write_b64 v6, v[56:57] offset:1152
    ds_write_b64 v6, v[58:59] offset:1184
    ds_write_b64 v6, v[60:61] offset:3456
    ds_write_b64 v6, v[62:63] offset:3488
    ds_read_b64_tr_b16 v[112:113], v7 offset:0
    ds_read_b64_tr_b16 v[114:115], v7 offset:288
    ds_read_b64_tr_b16 v[116:117], v7 offset:1152
    ds_read_b64_tr_b16 v[118:119], v7 offset:1440
    ds_read_b64_tr_b16 v[120:121], v7 offset:2304
    ds_read_b64_tr_b16 v[122:123], v7 offset:2592
    ds_read_b64_tr_b16 v[124:125], v7 offset:3456
    ds_read_b64_tr_b16 v[126:127], v7 offset:3744
    buffer_store_dwordx4 v[96:99], v2, s[24:27], s74 offen offset:0 sc1
    buffer_store_dwordx4 v[100:103], v2, s[24:27], s74 offen offset:2048 sc1
    buffer_store_dwordx4 v[104:107], v2, s[24:27], s74 offen offset:1024 sc1
    buffer_store_dwordx4 v[108:111], v2, s[24:27], s74 offen offset:3072 sc1
    s_waitcnt lgkmcnt(0)
    buffer_store_dwordx4 v[112:115], v2, s[24:27], s75 offen offset:0 sc1
    buffer_store_dwordx4 v[116:119], v2, s[24:27], s75 offen offset:2048 sc1
    buffer_store_dwordx4 v[120:123], v2, s[24:27], s75 offen offset:1024 sc1
    buffer_store_dwordx4 v[124:127], v2, s[24:27], s75 offen offset:3072 sc1
    s_waitcnt vmcnt(0)
    s_mov_b64 exec, 0xff
    buffer_store_dwordx4 v[92:95], v30, s[24:27], s77 offen offset:256 sc1
    s_mov_b64 exec, -1
L_P2:
    s_setprio 0
    s_mul_i32 s48, s69, 12288
    v_and_b32 v12, 31, v1
    v_lshrrev_b32 v13, 5, v1
    v_bfe_u32 v14, v1, 1, 3
    v_xor_b32 v14, v14, v13
    v_lshlrev_b32 v14, 4, v14
    v_lshl_add_u32 v12, v12, 7, v14
    v_add_u32 v2, s48, v12
    v_xor_b32 v3, 32, v2
    v_xor_b32 v4, 64, v2
    v_xor_b32 v6, 96, v2
    v_lshrrev_b32 v12, 3, v1
    s_lshl_b32 s74, s71, 6
    v_add_u32 v12, s74, v12
    v_and_b32 v13, 7, v1
    v_lshrrev_b32 v14, 4, v1
    v_xor_b32 v13, v13, v14
    v_lshlrev_b32 v13, 4, v13
    v_lshl_add_u32 v8, v12, 10, v13
    v_xor_b32 v9, 64, v8
    v_lshlrev_b32 v10, 4, v1
    s_lshl_b32 s74, s69, 2
    s_add_u32 s74, s74, 150160
    v_mov_b32 v16, s74
L_lf:
    ds_read_b32 v17, v16
    s_waitcnt lgkmcnt(0)
    v_cmp_ne_u32 vcc, 0, v17
    s_cbranch_vccz L_lfok
    s_sleep 2
    s_branch L_lf
L_lfok:
    ds_read_b128 v[224:227], v2 offset:0
    ds_read_b128 v[228:231], v2 offset:4096
    ds_read_b128 v[232:235], v3 offset:0
    ds_read_b128 v[236:239], v3 offset:4096
    ds_read_b128 v[240:243], v4 offset:0
    ds_read_b128 v[244:247], v4 offset:4096
    ds_read_b128 v[248:251], v6 offset:0
    ds_read_b128 v[252:255], v6 offset:4096
    ds_read_b128 v[32:35], v2 offset:8192
    ds_read_b128 v[36:39], v2 offset:57344
    ds_read_b128 v[40:43], v3 offset:8192
    ds_read_b128 v[44:47], v3 offset:57344
    ds_read_b128 v[48:51], v4 offset:8192
    ds_read_b128 v[52:55], v4 offset:57344
    ds_read_b128 v[56:59], v6 offset:8192
    ds_read_b128 v[60:63], v6 offset:57344
    v_mov_b32 v5, 10
    s_waitcnt lgkmcnt(0)
    ds_write_b32 v31, v5
    s_lshr_b32 s76, s72, 1
    s_add_u32 s76, s76, 3
    s_bitcmp0_b32 s76, 1
    s_cselect_b64 s[40:41], s[52:53], s[54:55]
    s_and_b32 s74, s76, 1
    s_lshl_b32 s74, s74, 7
    s_lshl_b32 s75, s69, 8
    s_add_u32 s74, s74, s75
    s_add_u32 m0, s48, 0
    s_nop 0
    buffer_load_dwordx4 v8, s[40:43], s74 offen lds
    s_add_u32 m0, m0, 1024
    s_add_u32 s74, s74, 8192
    buffer_load_dwordx4 v9, s[40:43], s74 offen lds
    s_add_u32 m0, m0, 1024
    s_add_u32 s74, s74, 8192
    buffer_load_dwordx4 v8, s[40:43], s74 offen lds
    s_add_u32 m0, m0, 1024
    s_add_u32 s74, s74, 8192
    buffer_load_dwordx4 v9, s[40:43], s74 offen lds
    s_add_u32 m0, m0, 1024
    s_add_u32 s74, s74, 8192
    buffer_load_dwordx4 v8, s[40:43], s74 offen lds
    s_add_u32 m0, m0, 1024
    s_add_u32 s74, s74, 8192
    buffer_load_dwordx4 v9, s[40:43], s74 offen lds
    s_add_u32 m0, m0, 1024
    s_add_u32 s74, s74, 8192
    buffer_load_dwordx4 v8, s[40:43], s74 offen lds
    s_add_u32 m0, m0, 1024
    s_add_u32 s74, s74, 8192
    buffer_load_dwordx4 v9, s[40:43], s74 offen lds
L_nog3:
    s_lshl_b32 s74, s70, 13
    s_lshl_b32 s75, s69, 11
    s_add_u32 s74, s74, s75
    s_add_u32 s74, s74, 10748160
    v_lshlrev_b32 v25, 9, v1
    s_mov_b64 exec, 15
L_flC:
    buffer_load_dwordx4 v[16:19], v25, s[24:27], s74 offen sc1
    s_waitcnt vmcnt(0)
L_flchkC:
    v_cmp_ne_u64 vcc, s[60:61], v[16:17]
    s_add_u32 s79, s79, 1
    s_cbranch_vccz L_flokC
    s_cmp_lt_u32 s79, 2097152
    s_cbranch_scc1 L_flC
L_flokC:
    s_mov_b64 exec, -1
    s_lshr_b32 s76, s72, 1
    s_add_u32 s76, s76, 2
    s_and_b32 s76, s76, 3
    s_lshl_b32 s74, s69, 2
    s_add_u32 s74, s74, s76
    s_lshl_b32 s74, s74, 13
    buffer_load_dwordx4 v[128:131], v10, s[32:35], s74 offen offset:0 sc1
    buffer_load_dwordx4 v[132:135], v10, s[32:35], s74 offen offset:1024 sc1
    buffer_load_dwordx4 v[136:139], v10, s[32:35], s74 offen offset:2048 sc1
    buffer_load_dwordx4 v[140:143], v10, s[32:35], s74 offen offset:3072 sc1
    s_add_u32 s74, s74, 4096
    buffer_load_dwordx4 v[144:147], v10, s[32:35], s74 offen offset:0 sc1
    buffer_load_dwordx4 v[148:151], v10, s[32:35], s74 offen offset:1024 sc1
    buffer_load_dwordx4 v[152:155], v10, s[32:35], s74 offen offset:2048 sc1
    buffer_load_dwordx4 v[156:159], v10, s[32:35], s74 offen offset:3072 sc1
    s_waitcnt vmcnt(6)
    v_mfma_f32_32x32x16_bf16 v[64:79], v[128:131], v[32:35], 0
    s_lshr_b32 s76, s72, 1
    s_add_u32 s76, s76, 0
    s_and_b32 s76, s76, 3
    s_lshl_b32 s74, s69, 2
    s_add_u32 s74, s74, s76
    s_lshl_b32 s74, s74, 13
    buffer_load_dwordx4 v[160:163], v10, s[32:35], s74 offen offset:0 sc1
    v_mfma_f32_32x32x16_bf16 v[80:95], v[128:131], v[36:39], 0
    v_mfma_f32_32x32x16_bf16 v[96:111], v[132:135], v[32:35], 0
    buffer_load_dwordx4 v[164:167], v10, s[32:35], s74 offen offset:1024 sc1
    v_mfma_f32_32x32x16_bf16 v[112:127], v[132:135], v[36:39], 0
    ds_read_b128 v[32:35], v2 offset:49152
    ds_read_b128 v[36:39], v2 offset:53248
    s_waitcnt vmcnt(6)
    v_mfma_f32_32x32x16_bf16 v[64:79], v[136:139], v[40:43], v[64:79]
    buffer_load_dwordx4 v[168:171], v10, s[32:35], s74 offen offset:2048 sc1
    v_mfma_f32_32x32x16_bf16 v[80:95], v[136:139], v[44:47], v[80:95]
    v_mfma_f32_32x32x16_bf16 v[96:111], v[140:143], v[40:43], v[96:111]
    buffer_load_dwordx4 v[172:175], v10, s[32:35], s74 offen offset:3072 sc1
    v_mfma_f32_32x32x16_bf16 v[112:127], v[140:143], v[44:47], v[112:127]
    ds_read_b128 v[40:43], v3 offset:49152
    ds_read_b128 v[44:47], v3 offset:53248
    s_waitcnt vmcnt(6)
    v_mfma_f32_32x32x16_bf16 v[64:79], v[144:147], v[48:51], v[64:79]
    s_add_u32 s74, s74, 4096
    buffer_load_dwordx4 v[176:179], v10, s[32:35], s74 offen offset:0 sc1
    v_mfma_f32_32x32x16_bf16 v[80:95], v[144:147], v[52:55], v[80:95]
    v_mfma_f32_32x32x16_bf16 v[96:111], v[148:151], v[48:51], v[96:111]
    buffer_load_dwordx4 v[180:183], v10, s[32:35], s74 offen offset:1024 sc1
    v_mfma_f32_32x32x16_bf16 v[112:127], v[148:151], v[52:55], v[112:127]
    ds_read_b128 v[48:51], v4 offset:49152
    ds_read_b128 v[52:55], v4 offset:53248
    s_waitcnt vmcnt(6)
    v_mfma_f32_32x32x16_bf16 v[64:79], v[152:155], v[56:59], v[64:79]
    buffer_load_dwordx4 v[184:187], v10, s[32:35], s74 offen offset:2048 sc1
    v_mfma_f32_32x32x16_bf16 v[80:95], v[152:155], v[60:63], v[80:95]
    v_mfma_f32_32x32x16_bf16 v[96:111], v[156:159], v[56:59], v[96:111]
    buffer_load_dwordx4 v[188:191], v10, s[32:35], s74 offen offset:3072 sc1
    v_mfma_f32_32x32x16_bf16 v[112:127], v[156:159], v[60:63], v[112:127]
    ds_read_b128 v[56:59], v6 offset:49152
    ds_read_b128 v[60:63], v6 offset:53248
    s_waitcnt vmcnt(6)
    v_mfma_f32_32x32x16_bf16 v[64:79], v[160:163], v[224:227], v[64:79]
    s_lshr_b32 s76, s72, 1
    s_add_u32 s76, s76, 1
    s_and_b32 s76, s76, 3
    s_lshl_b32 s74, s69, 2
    s_add_u32 s74, s74, s76
    s_lshl_b32 s74, s74, 13
    buffer_load_dwordx4 v[192:195], v10, s[32:35], s74 offen offset:0 sc1
    v_mfma_f32_32x32x16_bf16 v[80:95], v[160:163], v[228:231], v[80:95]
    v_mfma_f32_32x32x16_bf16 v[96:111], v[164:167], v[224:227], v[96:111]
    buffer_load_dwordx4 v[196:199], v10, s[32:35], s74 offen offset:1024 sc1
    v_mfma_f32_32x32x16_bf16 v[112:127], v[164:167], v[228:231], v[112:127]
    ds_read_b128 v[224:227], v2 offset:0
    ds_read_b128 v[228:231], v2 offset:4096
    s_waitcnt vmcnt(6)
    v_mfma_f32_32x32x16_bf16 v[64:79], v[168:171], v[232:235], v[64:79]
    buffer_load_dwordx4 v[200:203], v10, s[32:35], s74 offen offset:2048 sc1
    v_mfma_f32_32x32x16_bf16 v[80:95], v[168:171], v[236:239], v[80:95]
    v_mfma_f32_32x32x16_bf16 v[96:111], v[172:175], v[232:235], v[96:111]
    buffer_load_dwordx4 v[204:207], v10, s[32:35], s74 offen offset:3072 sc1
    v_mfma_f32_32x32x16_bf16 v[112:127], v[172:175], v[236:239], v[112:127]
    ds_read_b128 v[232:235], v3 offset:0
    ds_read_b128 v[236:239], v3 offset:4096
    s_waitcnt vmcnt(6)
    v_mfma_f32_32x32x16_bf16 v[64:79], v[176:179], v[240:243], v[64:79]
    s_add_u32 s74, s74, 4096
    buffer_load_dwordx4 v[208:211], v10, s[32:35], s74 offen offset:0 sc1
    v_mfma_f32_32x32x16_bf16 v[80:95], v[176:179], v[244:247], v[80:95]
    v_mfma_f32_32x32x16_bf16 v[96:111], v[180:183], v[240:243], v[96:111]
    buffer_load_dwordx4 v[212:215], v10, s[32:35], s74 offen offset:1024 sc1
    v_mfma_f32_32x32x16_bf16 v[112:127], v[180:183], v[244:247], v[112:127]
    ds_read_b128 v[240:243], v4 offset:0
    ds_read_b128 v[244:247], v4 offset:4096
    s_waitcnt vmcnt(6)
    v_mfma_f32_32x32x16_bf16 v[64:79], v[184:187], v[248:251], v[64:79]
    buffer_load_dwordx4 v[216:219], v10, s[32:35], s74 offen offset:2048 sc1
    v_mfma_f32_32x32x16_bf16 v[80:95], v[184:187], v[252:255], v[80:95]
    v_mfma_f32_32x32x16_bf16 v[96:111], v[188:191], v[248:251], v[96:111]
    buffer_load_dwordx4 v[220:223], v10, s[32:35], s74 offen offset:3072 sc1
    v_mfma_f32_32x32x16_bf16 v[112:127], v[188:191], v[252:255], v[112:127]
    ds_read_b128 v[248:251], v6 offset:0
    ds_read_b128 v[252:255], v6 offset:4096
    s_waitcnt vmcnt(6) lgkmcnt(14)
    v_mfma_f32_32x32x16_bf16 v[64:79], v[192:195], v[32:35], v[64:79]
    s_lshr_b32 s76, s72, 1
    s_add_u32 s76, s76, 3
    s_and_b32 s76, s76, 3
    s_lshl_b32 s74, s69, 2
    s_add_u32 s74, s74, s76
    s_lshl_b32 s74, s74, 13
    buffer_load_dwordx4 v[128:131], v10, s[32:35], s74 offen offset:0 sc1
    v_mfma_f32_32x32x16_bf16 v[80:95], v[192:195], v[36:39], v[80:95]
    v_mfma_f32_32x32x16_bf16 v[96:111], v[196:199], v[32:35], v[96:111]
    buffer_load_dwordx4 v[132:135], v10, s[32:35], s74 offen offset:1024 sc1
    v_mfma_f32_32x32x16_bf16 v[112:127], v[196:199], v[36:39], v[112:127]
    s_waitcnt vmcnt(6) lgkmcnt(12)
    v_mfma_f32_32x32x16_bf16 v[64:79], v[200:203], v[40:43], v[64:79]
    buffer_load_dwordx4 v[136:139], v10, s[32:35], s74 offen offset:2048 sc1
    v_mfma_f32_32x32x16_bf16 v[80:95], v[200:203], v[44:47], v[80:95]
    v_mfma_f32_32x32x16_bf16 v[96:111], v[204:207], v[40:43], v[96:111]
    buffer_load_dwordx4 v[140:143], v10, s[32:35], s74 offen offset:3072 sc1
    v_mfma_f32_32x32x16_bf16 v[112:127], v[204:207], v[44:47], v[112:127]
    s_waitcnt vmcnt(6) lgkmcnt(10)
    v_mfma_f32_32x32x16_bf16 v[64:79], v[208:211], v[48:51], v[64:79]
    s_add_u32 s74, s74, 4096
    buffer_load_dwordx4 v[144:147], v10, s[32:35], s74 offen offset:0 sc1
    v_mfma_f32_32x32x16_bf16 v[80:95], v[208:211], v[52:55], v[80:95]
    v_mfma_f32_32x32x16_bf16 v[96:111], v[212:215], v[48:51], v[96:111]
    buffer_load_dwordx4 v[148:151], v10, s[32:35], s74 offen offset:1024 sc1
    v_mfma_f32_32x32x16_bf16 v[112:127], v[212:215], v[52:55], v[112:127]
    s_waitcnt vmcnt(6) lgkmcnt(8)
    v_mfma_f32_32x32x16_bf16 v[64:79], v[216:219], v[56:59], v[64:79]
    buffer_load_dwordx4 v[152:155], v10, s[32:35], s74 offen offset:2048 sc1
    v_mfma_f32_32x32x16_bf16 v[80:95], v[216:219], v[60:63], v[80:95]
    v_mfma_f32_32x32x16_bf16 v[96:111], v[220:223], v[56:59], v[96:111]
    buffer_load_dwordx4 v[156:159], v10, s[32:35], s74 offen offset:3072 sc1
    v_mfma_f32_32x32x16_bf16 v[112:127], v[220:223], v[60:63], v[112:127]
    s_waitcnt vmcnt(6) lgkmcnt(6)
    v_mfma_f32_32x32x16_bf16 v[64:79], v[128:131], v[224:227], v[64:79]
    v_mfma_f32_32x32x16_bf16 v[80:95], v[128:131], v[228:231], v[80:95]
    v_mfma_f32_32x32x16_bf16 v[96:111], v[132:135], v[224:227], v[96:111]
    v_mfma_f32_32x32x16_bf16 v[112:127], v[132:135], v[228:231], v[112:127]
    s_waitcnt vmcnt(4) lgkmcnt(4)
    v_mfma_f32_32x32x16_bf16 v[64:79], v[136:139], v[232:235], v[64:79]
    v_mfma_f32_32x32x16_bf16 v[80:95], v[136:139], v[236:239], v[80:95]
    v_mfma_f32_32x32x16_bf16 v[96:111], v[140:143], v[232:235], v[96:111]
    v_mfma_f32_32x32x16_bf16 v[112:127], v[140:143], v[236:239], v[112:127]
    s_waitcnt vmcnt(2) lgkmcnt(2)
    v_mfma_f32_32x32x16_bf16 v[64:79], v[144:147], v[240:243], v[64:79]
    v_mfma_f32_32x32x16_bf16 v[80:95], v[144:147], v[244:247], v[80:95]
    v_mfma_f32_32x32x16_bf16 v[96:111], v[148:151], v[240:243], v[96:111]
    v_mfma_f32_32x32x16_bf16 v[112:127], v[148:151], v[244:247], v[112:127]
    s_waitcnt vmcnt(0) lgkmcnt(0)
    v_mfma_f32_32x32x16_bf16 v[64:79], v[152:155], v[248:251], v[64:79]
    v_mfma_f32_32x32x16_bf16 v[80:95], v[152:155], v[252:255], v[80:95]
    v_mfma_f32_32x32x16_bf16 v[96:111], v[156:159], v[248:251], v[96:111]
    v_mfma_f32_32x32x16_bf16 v[112:127], v[156:159], v[252:255], v[112:127]
    s_mov_b32 m0, s48
    s_nop 7
    ds_write_addtid_b32 v64 offset:0
    ds_write_addtid_b32 v65 offset:256
    ds_write_addtid_b32 v66 offset:512
    ds_write_addtid_b32 v67 offset:768
    ds_write_addtid_b32 v68 offset:1024
    ds_write_addtid_b32 v69 offset:1280
    ds_write_addtid_b32 v70 offset:1536
    ds_write_addtid_b32 v71 offset:1792
    ds_write_addtid_b32 v72 offset:2048
    ds_write_addtid_b32 v73 offset:2304
    ds_write_addtid_b32 v74 offset:2560
    ds_write_addtid_b32 v75 offset:2816
    ds_write_addtid_b32 v76 offset:3072
    ds_write_addtid_b32 v77 offset:3328
    ds_write_addtid_b32 v78 offset:3584
    ds_write_addtid_b32 v79 offset:3840
    ds_write_addtid_b32 v80 offset:4096
    ds_write_addtid_b32 v81 offset:4352
    ds_write_addtid_b32 v82 offset:4608
    ds_write_addtid_b32 v83 offset:4864
    ds_write_addtid_b32 v84 offset:5120
    ds_write_addtid_b32 v85 offset:5376
    ds_write_addtid_b32 v86 offset:5632
    ds_write_addtid_b32 v87 offset:5888
    ds_write_addtid_b32 v88 offset:6144
    ds_write_addtid_b32 v89 offset:6400
    ds_write_addtid_b32 v90 offset:6656
    ds_write_addtid_b32 v91 offset:6912
    ds_write_addtid_b32 v92 offset:7168
    ds_write_addtid_b32 v93 offset:7424
    ds_write_addtid_b32 v94 offset:7680
    ds_write_addtid_b32 v95 offset:7936
    ds_write_addtid_b32 v96 offset:49152
    ds_write_addtid_b32 v97 offset:49408
    ds_write_addtid_b32 v98 offset:49664
    ds_write_addtid_b32 v99 offset:49920
    ds_write_addtid_b32 v100 offset:50176
    ds_write_addtid_b32 v101 offset:50432
    ds_write_addtid_b32 v102 offset:50688
    ds_write_addtid_b32 v103 offset:50944
    ds_write_addtid_b32 v104 offset:51200
    ds_write_addtid_b32 v105 offset:51456
    ds_write_addtid_b32 v106 offset:51712
    ds_write_addtid_b32 v107 offset:51968
    ds_write_addtid_b32 v108 offset:52224
    ds_write_addtid_b32 v109 offset:52480
    ds_write_addtid_b32 v110 offset:52736
    ds_write_addtid_b32 v111 offset:52992
    ds_write_addtid_b32 v112 offset:53248
    ds_write_addtid_b32 v113 offset:53504
    ds_write_addtid_b32 v114 offset:53760
    ds_write_addtid_b32 v115 offset:54016
    ds_write_addtid_b32 v116 offset:54272
    ds_write_addtid_b32 v117 offset:54528
    ds_write_addtid_b32 v118 offset:54784
    ds_write_addtid_b32 v119 offset:55040
    ds_write_addtid_b32 v120 offset:55296
    ds_write_addtid_b32 v121 offset:55552
    ds_write_addtid_b32 v122 offset:55808
    ds_write_addtid_b32 v123 offset:56064
    ds_write_addtid_b32 v124 offset:56320
    ds_write_addtid_b32 v125 offset:56576
    ds_write_addtid_b32 v126 offset:56832
    ds_write_addtid_b32 v127 offset:57088
    s_waitcnt lgkmcnt(0)
    s_barrier
L_end:
    s_endpgm
L_codeend:
.section .rodata,"a"
.p2align 6
.amdhsa_kernel gated_mix__ssm_conv_s5__glu_gated_bilinear__prompt_kernel
  .amdhsa_next_free_vgpr 256
  .amdhsa_next_free_sgpr 102
  .amdhsa_accum_offset 256
  .amdhsa_group_segment_fixed_size 0
  .amdhsa_kernarg_size 136
  .amdhsa_user_sgpr_count 2
  .amdhsa_user_sgpr_kernarg_segment_ptr 1
  .amdhsa_system_sgpr_workgroup_id_x 1
  .amdhsa_float_denorm_mode_32 3
  .amdhsa_float_denorm_mode_16_64 3
.end_amdhsa_kernel
```
